```python
import torch

def _softmax(x, axis=-1):
    return torch.softmax(x, dim=axis)
def _gelu(x):
    return torch.nn.functional.gelu(x, approximate="tanh")
def _silu(x):
    return torch.nn.functional.silu(x)
def _sigmoid(x):
    return torch.sigmoid(x)
def _layernorm(x, axis=-1, eps=1e-5):
    m = x.mean(dim=axis, keepdim=True)
    v = x.var(dim=axis, keepdim=True, unbiased=False)
    return (x - m) / torch.sqrt(v + eps)
def _scatter_add(tgt, idx, src, axis=0):
    return tgt.clone().index_add_(axis, idx, src)
def _segment_sum(src, seg, n):
    out = torch.zeros((n,) + src.shape[1:], dtype=src.dtype)
    return out.index_add_(0, seg, src)
def _pad(x, pw):
    flat = tuple(v for pair in reversed(pw) for v in pair)
    return torch.nn.functional.pad(x, flat)

kernel_name = 'concat_heads__grouped_kv_mqa__ssm_conv_h3__prompt'

def setup_inputs():

    _w = (lambda a: (lambda t: t.to(torch.bfloat16) if t.is_floating_point() else t)(torch.as_tensor(a)))
    def _A_setup():
        B, S, D, H = 1, 2048, 576, 32
        Dh = D // H
        return {
            "x": _w((lambda *s: torch.randn(*s, dtype=torch.bfloat16) * 0.05)(B, S, D)),
            "wq": _w((lambda *s: torch.randn(*s, dtype=torch.bfloat16) * 0.8)(D, H * Dh)),
            "wk": _w((lambda *s: torch.randn(*s, dtype=torch.bfloat16) * 0.8)(D, Dh)),
            "wv": _w((lambda *s: torch.randn(*s, dtype=torch.bfloat16) * 0.05)(D, Dh)),
            "wo": _w((lambda *s: torch.randn(*s, dtype=torch.bfloat16) * 0.05)(H * Dh, D)),
        }
    _A_in = _A_setup()

    def _B_setup():
        B, S, D = 1, 2048, 576
        ks = 4
        return {
            "q": _w((lambda *s: torch.randn(*s, dtype=torch.bfloat16) * 0.05)(B, S, D)),
            "k": _w((lambda *s: torch.randn(*s, dtype=torch.bfloat16) * 0.2)(B, S, D)),
            "v": _w((lambda *s: torch.randn(*s, dtype=torch.bfloat16) * 0.2)(B, S, D)),
            "shift_k": _w((lambda *s: torch.randn(*s, dtype=torch.bfloat16) * 0.2)(D, ks) * 0.5),
            "ssm_k": _w((lambda *s: torch.randn(*s, dtype=torch.bfloat16) * 0.8)(D, S) * (1.0 / S ** 0.5)),
            "ssm_D": _w((lambda *s: torch.randn(*s, dtype=torch.bfloat16) * 0.2)(D)),
        }
    _B_in = _B_setup()

    return {
        "A_x": _A_in["x"],
        "A_wq": _A_in["wq"],
        "A_wk": _A_in["wk"],
        "A_wv": _A_in["wv"],
        "A_wo": _A_in["wo"],
        "B_q": _B_in["q"],
        "B_k": _B_in["k"],
        "B_v": _B_in["v"],
        "B_shift_k": _B_in["shift_k"],
        "B_ssm_k": _B_in["ssm_k"],
        "B_ssm_D": _B_in["ssm_D"],
    }

def reference(A_x, A_wq, A_wk, A_wv, A_wo, B_q, B_k, B_v, B_shift_k, B_ssm_k, B_ssm_D):
    def _A_ref(x, wq, wk, wv, wo):
        B, S, D = x.shape
        H = 32
        Dh = D // H
        q = (lambda x, *d: x.permute(*d))((x @ wq).reshape(B, S, H, Dh), 0, 2, 1, 3)
        k = x @ wk
        v = x @ wv
        scores = torch.einsum("bhqd,bkd->bhqk", q, k) * (Dh ** -0.5)
        p = _softmax(scores, axis=-1)
        o = torch.einsum("bhqk,bkd->bhqd", p, v)
        return (lambda x, *d: x.permute(*d))(o, 0, 2, 1, 3).reshape(B, S, H * Dh) @ wo

    def _B_ref(q, k, v, shift_k, ssm_k, ssm_D):
        B, S, D = q.shape
        ks = shift_k.shape[-1]
        k_pad = _pad(k, ((0, 0), (ks - 1, 0), (0, 0)))
        k_shift = torch.zeros_like(k)
        for t in range(ks):
            k_shift = k_shift + k_pad[:, t:t + S, :] * shift_k[:, ks - 1 - t][None, None, :]
        kv = k_shift * v
        L = 2 * S
        kv_pad = _pad(kv, ((0, 0), (0, S), (0, 0)))
        kf_pad = _pad(ssm_k, ((0, 0), (0, S)))
        kv_f = (lambda x, axes=(-2,-1): torch.fft.rfft2(x.float(), dim=axes))(kv_pad[:, None, :, :], axes=(1, 2))
        kf_f = (lambda x, axes=(-2,-1): torch.fft.rfft2(x.float(), dim=axes))(kf_pad[:, None, :], axes=(1, 2))
        kf_f = (lambda x, *d: x.permute(*d))(kf_f, 1, 2, 0)
        y_f = kv_f * kf_f[None, :, :, :]
        y = (lambda x, s, axes=(-2,-1): torch.fft.irfft2(x, s=s, dim=axes).to(torch.bfloat16))(y_f, (1, L), axes=(1, 2))[:, 0, :S, :]
        y = y + kv * ssm_D[None, None, :]
        return q * y

    a = _A_ref(A_x, A_wq, A_wk, A_wv, A_wo)
    b = _B_ref(B_q, B_k, B_v, B_shift_k, B_ssm_k, B_ssm_D)
    return torch.concatenate([a, b], axis=-1)
```

```asm
; @launch grid=(256,1,1) block=(768,1,1) lds=163840
.amdgcn_target "amdgcn-amd-amdhsa--gfx950"
.text
.globl concat_heads__grouped_kv_mqa__ssm_conv_h3__prompt_kernel
.p2align 8
.type concat_heads__grouped_kv_mqa__ssm_conv_h3__prompt_kernel,@function
concat_heads__grouped_kv_mqa__ssm_conv_h3__prompt_kernel:
    s_cmp_ge_u32 s2, 256
    s_cbranch_scc1 L_end
    s_load_dwordx16 s[8:23], s[0:1], 0
    s_load_dwordx8 s[24:31], s[0:1], 64
    s_load_dwordx4 s[32:35], s[0:1], 96
    v_and_b32 v1, 63, v0
    v_lshrrev_b32 v2, 6, v0
    v_mov_b32 v3, 0
    v_readfirstlane_b32 s3, v2
    s_and_b32 s4, s2, 31
    s_lshr_b32 s5, s2, 5
    s_cmp_lt_u32 s3, 8
    s_cbranch_scc1 L_att
    s_sub_u32 s7, s3, 8
    s_setprio 2
    v_subrev_u32 v5, 512, v0
    v_mul_u32_u24 v6, 21846, v5
    v_lshrrev_b32 v6, 16, v6
    v_mul_u32_u24 v6, 12, v6
    v_lshlrev_b32 v7, 4, v5
    v_sub_u32 v16, v7, v6
    v_add_u32 v5, 256, v5
    v_mul_u32_u24 v6, 21846, v5
    v_lshrrev_b32 v6, 16, v6
    v_mul_u32_u24 v6, 12, v6
    v_lshlrev_b32 v7, 4, v5
    v_sub_u32 v17, v7, v6
    v_add_u32 v5, 256, v5
    v_mul_u32_u24 v6, 21846, v5
    v_lshrrev_b32 v6, 16, v6
    v_mul_u32_u24 v6, 12, v6
    v_lshlrev_b32 v7, 4, v5
    v_sub_u32 v18, v7, v6
    v_add_u32 v5, 256, v5
    v_mul_u32_u24 v6, 21846, v5
    v_lshrrev_b32 v6, 16, v6
    v_mul_u32_u24 v6, 12, v6
    v_lshlrev_b32 v7, 4, v5
    v_sub_u32 v19, v7, v6
    v_add_u32 v5, 256, v5
    v_mul_u32_u24 v6, 21846, v5
    v_lshrrev_b32 v6, 16, v6
    v_mul_u32_u24 v6, 12, v6
    v_lshlrev_b32 v7, 4, v5
    v_sub_u32 v20, v7, v6
    v_add_u32 v5, 256, v5
    v_mul_u32_u24 v6, 21846, v5
    v_lshrrev_b32 v6, 16, v6
    v_mul_u32_u24 v6, 12, v6
    v_lshlrev_b32 v7, 4, v5
    v_sub_u32 v21, v7, v6
    v_add_u32 v5, 256, v5
    v_mul_u32_u24 v6, 21846, v5
    v_lshrrev_b32 v6, 16, v6
    v_mul_u32_u24 v6, 12, v6
    v_lshlrev_b32 v7, 4, v5
    v_sub_u32 v22, v7, v6
    v_lshlrev_b32 v4, 4, v1
    s_and_b32 s61, s5, 3
    s_lshl_b32 s61, s61, 2
    s_add_u32 s61, s61, s7
    s_lshl_b32 s61, s61, 2
    s_lshl_b32 s60, s4, 6
    s_add_u32 s60, s60, s61
    s_mul_i32 s60, s60, 1152
    s_lshl_b32 s62, s7, 5
    v_xor_b32 v24, s62, v4
    s_add_u32 s62, s62, 16
    v_xor_b32 v25, s62, v4
    v_lshrrev_b32 v6, 5, v1
    s_lshl_b32 s62, s7, 2
    v_add_u32 v7, s62, v6
    v_and_b32 v5, 31, v1
    v_xor_b32 v26, v5, v7
    v_xor_b32 v27, 2, v26
    v_mul_u32_u24 v6, 1152, v6
    v_lshl_add_u32 v26, v26, 4, v6
    v_lshl_add_u32 v27, v27, 4, v6
    s_lshl_b32 s63, s7, 10
    s_waitcnt lgkmcnt(0)
    s_cmp_lt_u32 s5, 4
    s_cselect_b32 s48, s12, s14
    s_cselect_b32 s49, s13, s15
    s_mov_b32 s50, 20736
    s_mov_b32 s51, 0x00020000
    s_mov_b32 s40, s8
    s_mov_b32 s41, s9
    s_mov_b32 s42, 2359296
    s_mov_b32 s43, 0x00020000
    s_add_u32 m0, s63, 128000
    s_nop 0
    buffer_load_dwordx4 v16, s[48:51], 0 offen lds
    s_add_u32 m0, s63, 132096
    s_nop 0
    buffer_load_dwordx4 v17, s[48:51], 0 offen lds
    s_add_u32 m0, s63, 136192
    s_nop 0
    buffer_load_dwordx4 v18, s[48:51], 0 offen lds
    s_add_u32 m0, s63, 140288
    s_nop 0
    buffer_load_dwordx4 v19, s[48:51], 0 offen lds
    s_add_u32 m0, s63, 144384
    s_nop 0
    buffer_load_dwordx4 v20, s[48:51], 0 offen lds
    s_add_u32 m0, s63, 148480
    s_nop 0
    buffer_load_dwordx4 v21, s[48:51], 0 offen lds
    s_add_u32 m0, s63, 152576
    s_nop 0
    buffer_load_dwordx4 v22, s[48:51], 0 offen lds
    s_mul_i32 s62, s61, 640
    s_mov_b32 exec_hi, 0xff
    s_add_u32 m0, s62, 0
    s_add_u32 s64, s60, 0
    buffer_load_dwordx4 v24, s[40:43], s64 offen lds
    s_add_u32 m0, s62, 640
    s_add_u32 s64, s60, 1152
    buffer_load_dwordx4 v24, s[40:43], s64 offen lds
    s_add_u32 m0, s62, 1280
    s_add_u32 s64, s60, 2304
    buffer_load_dwordx4 v25, s[40:43], s64 offen lds
    s_add_u32 m0, s62, 1920
    s_add_u32 s64, s60, 3456
    buffer_load_dwordx4 v25, s[40:43], s64 offen lds
    s_mov_b32 exec_hi, -1
    s_lshl_b32 s62, s61, 9
    s_add_u32 m0, s62, 40960
    s_add_u32 s64, s60, 640
    buffer_load_dwordx4 v26, s[40:43], s64 offen lds
    s_add_u32 m0, s62, 41984
    s_add_u32 s64, s60, 2944
    buffer_load_dwordx4 v27, s[40:43], s64 offen lds
    s_mov_b32 s36, s34
    s_mov_b32 s37, s35
    s_mov_b32 s38, 16777216
    s_mov_b32 s39, 0x00020000
    buffer_load_dword v2, v3, s[36:39], 0 offen sc1
    v_and_b32 v4, 15, v1
    v_lshrrev_b32 v5, 4, v1
    v_lshlrev_b32 v7, 2, v1
    v_add_u32 v7, 157184, v7
    ds_write_b32 v7, v3
    s_waitcnt lgkmcnt(0)
L_h_b0:
    s_barrier
    s_cmp_lt_u32 s7, 2
    s_cbranch_scc1 L_h_kv
    s_waitcnt vmcnt(0)
    v_mov_b32 v3, 157184
    v_mov_b32 v6, 1
    s_mov_b64 exec, 1
    ds_add_u32 v3, v6 offset:16
    ds_add_u32 v3, v6
    s_mov_b64 exec, -1
    s_waitcnt vmcnt(0)
    v_readfirstlane_b32 s6, v2
    s_nop 0
    s_add_u32 s6, s6, 2654435769
    v_mov_b32 v3, 157192
    v_mov_b32 v6, 1
    s_mov_b64 exec, 1
    ds_add_rtn_u32 v6, v3, v6
    s_waitcnt lgkmcnt(0)
    v_readfirstlane_b32 s60, v6
    s_mov_b64 exec, -1
    s_cmp_lg_u32 s60, 3
    s_cbranch_scc1 L_nl1
    v_mov_b32 v3, 157216
    ds_read_b64 v[6:7], v3
    s_lshl_b32 s60, s2, 5
    s_add_u32 s60, s60, 262144
    v_mov_b32 v3, 0
    s_waitcnt lgkmcnt(0)
    v_add_f32 v7, v6, v7
    v_mov_b32 v6, s6
    s_mov_b64 exec, 1
    buffer_store_dwordx2 v[6:7], v3, s[36:39], s60 offen sc1
    s_mov_b64 exec, -1
L_nl1:
    s_cmp_eq_u32 s7, 3
    s_cbranch_scc1 L_h_p1
    s_mov_b32 s40, s10
    s_mov_b32 s41, s11
    s_mov_b32 s42, 663552
    s_mov_b32 s43, 0x00020000
    v_add_u32 v5, 3392, v1
    v_mul_u32_u24 v6, 7282, v5
    v_lshrrev_b32 v6, 16, v6
    v_mul_u32_u24 v7, 1008, v6
    v_lshl_add_u32 v120, v5, 4, v7
    v_add_u32 v5, 3456, v1
    v_mul_u32_u24 v6, 7282, v5
    v_lshrrev_b32 v6, 16, v6
    v_mul_u32_u24 v7, 1008, v6
    v_lshl_add_u32 v121, v5, 4, v7
    v_add_u32 v5, 3520, v1
    v_mul_u32_u24 v6, 7282, v5
    v_lshrrev_b32 v6, 16, v6
    v_mul_u32_u24 v7, 1008, v6
    v_lshl_add_u32 v122, v5, 4, v7
    v_add_u32 v5, 3584, v1
    v_mul_u32_u24 v6, 7282, v5
    v_lshrrev_b32 v6, 16, v6
    v_mul_u32_u24 v7, 1008, v6
    v_lshl_add_u32 v123, v5, 4, v7
    v_add_u32 v5, 3648, v1
    v_mul_u32_u24 v6, 7282, v5
    v_lshrrev_b32 v6, 16, v6
    v_mul_u32_u24 v7, 1008, v6
    v_lshl_add_u32 v124, v5, 4, v7
    v_add_u32 v5, 3712, v1
    v_mul_u32_u24 v6, 7282, v5
    v_lshrrev_b32 v6, 16, v6
    v_mul_u32_u24 v7, 1008, v6
    v_lshl_add_u32 v125, v5, 4, v7
    v_add_u32 v5, 3776, v1
    v_mul_u32_u24 v6, 7282, v5
    v_lshrrev_b32 v6, 16, v6
    v_mul_u32_u24 v7, 1008, v6
    v_lshl_add_u32 v126, v5, 4, v7
    v_add_u32 v5, 3840, v1
    v_mul_u32_u24 v6, 7282, v5
    v_lshrrev_b32 v6, 16, v6
    v_mul_u32_u24 v7, 1008, v6
    v_lshl_add_u32 v127, v5, 4, v7
    v_add_u32 v5, 3904, v1
    v_mul_u32_u24 v6, 7282, v5
    v_lshrrev_b32 v6, 16, v6
    v_mul_u32_u24 v7, 1008, v6
    v_lshl_add_u32 v128, v5, 4, v7
    v_add_u32 v5, 3968, v1
    v_mul_u32_u24 v6, 7282, v5
    v_lshrrev_b32 v6, 16, v6
    v_mul_u32_u24 v7, 1008, v6
    v_lshl_add_u32 v129, v5, 4, v7
    v_add_u32 v5, 4032, v1
    v_mul_u32_u24 v6, 7282, v5
    v_lshrrev_b32 v6, 16, v6
    v_mul_u32_u24 v7, 1008, v6
    v_lshl_add_u32 v130, v5, 4, v7
    v_add_u32 v5, 4096, v1
    v_mul_u32_u24 v6, 7282, v5
    v_lshrrev_b32 v6, 16, v6
    v_mul_u32_u24 v7, 1008, v6
    v_lshl_add_u32 v131, v5, 4, v7
    v_add_u32 v5, 4160, v1
    v_mul_u32_u24 v6, 7282, v5
    v_lshrrev_b32 v6, 16, v6
    v_mul_u32_u24 v7, 1008, v6
    v_lshl_add_u32 v132, v5, 4, v7
    v_add_u32 v5, 4224, v1
    v_mul_u32_u24 v6, 7282, v5
    v_lshrrev_b32 v6, 16, v6
    v_mul_u32_u24 v7, 1008, v6
    v_lshl_add_u32 v133, v5, 4, v7
    v_add_u32 v5, 4288, v1
    v_mul_u32_u24 v6, 7282, v5
    v_lshrrev_b32 v6, 16, v6
    v_mul_u32_u24 v7, 1008, v6
    v_lshl_add_u32 v134, v5, 4, v7
    v_add_u32 v5, 4352, v1
    v_mul_u32_u24 v6, 7282, v5
    v_lshrrev_b32 v6, 16, v6
    v_mul_u32_u24 v7, 1008, v6
    v_lshl_add_u32 v135, v5, 4, v7
    v_add_u32 v5, 4416, v1
    v_mul_u32_u24 v6, 7282, v5
    v_lshrrev_b32 v6, 16, v6
    v_mul_u32_u24 v7, 1008, v6
    v_lshl_add_u32 v136, v5, 4, v7
    v_add_u32 v5, 4480, v1
    v_mul_u32_u24 v6, 7282, v5
    v_lshrrev_b32 v6, 16, v6
    v_mul_u32_u24 v7, 1008, v6
    v_lshl_add_u32 v137, v5, 4, v7
    v_add_u32 v5, 4544, v1
    v_mul_u32_u24 v6, 7282, v5
    v_lshrrev_b32 v6, 16, v6
    v_mul_u32_u24 v7, 1008, v6
    v_lshl_add_u32 v138, v5, 4, v7
    v_add_u32 v5, 4608, v1
    v_mul_u32_u24 v6, 7282, v5
    v_lshrrev_b32 v6, 16, v6
    v_mul_u32_u24 v7, 1008, v6
    v_lshl_add_u32 v139, v5, 4, v7
    v_add_u32 v5, 4672, v1
    v_mul_u32_u24 v6, 7282, v5
    v_lshrrev_b32 v6, 16, v6
    v_mul_u32_u24 v7, 1008, v6
    v_lshl_add_u32 v140, v5, 4, v7
    v_add_u32 v5, 4736, v1
    v_mul_u32_u24 v6, 7282, v5
    v_lshrrev_b32 v6, 16, v6
    v_mul_u32_u24 v7, 1008, v6
    v_lshl_add_u32 v141, v5, 4, v7
    v_add_u32 v5, 4800, v1
    v_mul_u32_u24 v6, 7282, v5
    v_lshrrev_b32 v6, 16, v6
    v_mul_u32_u24 v7, 1008, v6
    v_lshl_add_u32 v142, v5, 4, v7
    v_add_u32 v5, 4864, v1
    v_mul_u32_u24 v6, 7282, v5
    v_lshrrev_b32 v6, 16, v6
    v_mul_u32_u24 v7, 1008, v6
    v_lshl_add_u32 v143, v5, 4, v7
    v_add_u32 v5, 4928, v1
    v_mul_u32_u24 v6, 7282, v5
    v_lshrrev_b32 v6, 16, v6
    v_mul_u32_u24 v7, 1008, v6
    v_lshl_add_u32 v144, v5, 4, v7
    v_add_u32 v5, 4992, v1
    v_mul_u32_u24 v6, 7282, v5
    v_lshrrev_b32 v6, 16, v6
    v_mul_u32_u24 v7, 1008, v6
    v_lshl_add_u32 v145, v5, 4, v7
    v_add_u32 v5, 5056, v1
    v_mul_u32_u24 v6, 7282, v5
    v_lshrrev_b32 v6, 16, v6
    v_mul_u32_u24 v7, 1008, v6
    v_lshl_add_u32 v146, v5, 4, v7
    v_add_u32 v5, 5120, v1
    v_mul_u32_u24 v6, 7282, v5
    v_lshrrev_b32 v6, 16, v6
    v_mul_u32_u24 v7, 1008, v6
    v_lshl_add_u32 v147, v5, 4, v7
    s_mul_i32 s63, s5, 144
    v_mov_b32 v3, 157188
    s_mov_b32 s89, 2097152
L_spin2:
    ds_read_b32 v6, v3
    s_waitcnt lgkmcnt(0)
    v_readfirstlane_b32 s88, v6
    s_nop 0
    s_cmp_ge_u32 s88, 2
    s_cbranch_scc1 L_spun3
    s_sleep 1
    s_sub_u32 s89, s89, 1
    s_cbranch_scc0 L_spin2
L_spun3:
    s_setprio 0
    s_mov_b32 m0, 128000
    s_nop 0
    buffer_load_dwordx4 v120, s[40:43], s63 offen lds
    s_mov_b32 m0, 129024
    s_nop 0
    buffer_load_dwordx4 v121, s[40:43], s63 offen lds
    s_mov_b32 m0, 130048
    s_nop 0
    buffer_load_dwordx4 v122, s[40:43], s63 offen lds
    s_mov_b32 m0, 131072
    s_nop 0
    buffer_load_dwordx4 v123, s[40:43], s63 offen lds
    s_mov_b32 m0, 132096
    s_nop 0
    buffer_load_dwordx4 v124, s[40:43], s63 offen lds
    s_mov_b32 m0, 133120
    s_nop 0
    buffer_load_dwordx4 v125, s[40:43], s63 offen lds
    s_mov_b32 m0, 134144
    s_nop 0
    buffer_load_dwordx4 v126, s[40:43], s63 offen lds
    s_mov_b32 m0, 135168
    s_nop 0
    buffer_load_dwordx4 v127, s[40:43], s63 offen lds
    s_mov_b32 m0, 136192
    s_nop 0
    buffer_load_dwordx4 v128, s[40:43], s63 offen lds
    s_mov_b32 m0, 137216
    s_nop 0
    buffer_load_dwordx4 v129, s[40:43], s63 offen lds
    s_mov_b32 m0, 138240
    s_nop 0
    buffer_load_dwordx4 v130, s[40:43], s63 offen lds
    s_mov_b32 m0, 139264
    s_nop 0
    buffer_load_dwordx4 v131, s[40:43], s63 offen lds
    s_mov_b32 m0, 140288
    s_nop 0
    buffer_load_dwordx4 v132, s[40:43], s63 offen lds
    s_mov_b32 m0, 141312
    s_nop 0
    buffer_load_dwordx4 v133, s[40:43], s63 offen lds
    s_mov_b32 m0, 142336
    s_nop 0
    buffer_load_dwordx4 v134, s[40:43], s63 offen lds
    s_mov_b32 m0, 143360
    s_nop 0
    buffer_load_dwordx4 v135, s[40:43], s63 offen lds
    s_mov_b32 m0, 144384
    s_nop 0
    buffer_load_dwordx4 v136, s[40:43], s63 offen lds
    s_mov_b32 m0, 145408
    s_nop 0
    buffer_load_dwordx4 v137, s[40:43], s63 offen lds
    s_mov_b32 m0, 146432
    s_nop 0
    buffer_load_dwordx4 v138, s[40:43], s63 offen lds
    s_mov_b32 m0, 147456
    s_nop 0
    buffer_load_dwordx4 v139, s[40:43], s63 offen lds
    s_mov_b32 m0, 148480
    s_nop 0
    buffer_load_dwordx4 v140, s[40:43], s63 offen lds
    s_mov_b32 m0, 149504
    s_nop 0
    buffer_load_dwordx4 v141, s[40:43], s63 offen lds
    s_mov_b32 m0, 150528
    s_nop 0
    buffer_load_dwordx4 v142, s[40:43], s63 offen lds
    s_mov_b32 m0, 151552
    s_nop 0
    buffer_load_dwordx4 v143, s[40:43], s63 offen lds
    s_mov_b32 m0, 152576
    s_nop 0
    buffer_load_dwordx4 v144, s[40:43], s63 offen lds
    s_mov_b32 m0, 153600
    s_nop 0
    buffer_load_dwordx4 v145, s[40:43], s63 offen lds
    s_mov_b32 m0, 154624
    s_nop 0
    buffer_load_dwordx4 v146, s[40:43], s63 offen lds
    s_mov_b32 m0, 155648
    s_nop 0
    buffer_load_dwordx4 v147, s[40:43], s63 offen lds
    s_setprio 2
    s_waitcnt vmcnt(0)
    v_mov_b32 v3, 157204
    v_mov_b32 v6, 1
    s_mov_b64 exec, 1
    ds_add_u32 v3, v6
    s_mov_b64 exec, -1
L_h_p1:
    v_mov_b32 v3, 157200
    s_mov_b32 s89, 2097152
L_spin4:
    ds_read_b32 v6, v3
    s_waitcnt lgkmcnt(0)
    v_readfirstlane_b32 s88, v6
    s_nop 0
    s_cmp_ge_u32 s88, 12
    s_cbranch_scc1 L_spun5
    s_sleep 2
    s_sub_u32 s89, s89, 1
    s_cbranch_scc0 L_spin4
L_spun5:
    s_mov_b32 s44, s20
    s_mov_b32 s45, s21
    s_mov_b32 s46, 2359296
    s_mov_b32 s47, 0x00020000
    s_mov_b32 s52, s22
    s_mov_b32 s53, s23
    s_mov_b32 s54, 2359296
    s_mov_b32 s55, 0x00020000
    s_mov_b32 s56, s24
    s_mov_b32 s57, s25
    s_mov_b32 s58, 4608
    s_mov_b32 s59, 0x00020000
    s_sub_u32 s63, 3, s7
    s_lshl_b32 s63, s63, 6
    v_add_u32 v6, s63, v1
    v_mul_u32_u24 v7, 3641, v6
    v_lshrrev_b32 v7, 16, v7
    s_lshl_b32 s60, s4, 6
    v_lshl_add_u32 v56, v7, 3, s60
    v_mul_u32_u24 v7, 18, v7
    v_sub_u32 v6, v6, v7
    s_mul_i32 s60, s5, 72
    v_lshl_add_u32 v57, v6, 2, s60
    v_mul_u32_u24 v6, 1152, v56
    v_lshl_add_u32 v6, v57, 1, v6
    v_subrev_u32 v7, 3456, v6
    buffer_load_dwordx2 v[8:9], v7, s[44:47], 0 offen
    v_subrev_u32 v7, 2304, v6
    buffer_load_dwordx2 v[10:11], v7, s[44:47], 0 offen
    v_subrev_u32 v7, 1152, v6
    buffer_load_dwordx2 v[12:13], v7, s[44:47], 0 offen
    s_mov_b32 s60, 0
    buffer_load_dwordx2 v[14:15], v6, s[44:47], s60 offen
    buffer_load_dwordx2 v[30:31], v6, s[52:55], s60 offen
    s_mov_b32 s60, 1152
    buffer_load_dwordx2 v[16:17], v6, s[44:47], s60 offen
    buffer_load_dwordx2 v[32:33], v6, s[52:55], s60 offen
    s_mov_b32 s60, 2304
    buffer_load_dwordx2 v[18:19], v6, s[44:47], s60 offen
    buffer_load_dwordx2 v[34:35], v6, s[52:55], s60 offen
    s_mov_b32 s60, 3456
    buffer_load_dwordx2 v[20:21], v6, s[44:47], s60 offen
    buffer_load_dwordx2 v[36:37], v6, s[52:55], s60 offen
    s_mov_b32 s60, 4608
    buffer_load_dwordx2 v[22:23], v6, s[44:47], s60 offen
    buffer_load_dwordx2 v[38:39], v6, s[52:55], s60 offen
    s_mov_b32 s60, 5760
    buffer_load_dwordx2 v[24:25], v6, s[44:47], s60 offen
    buffer_load_dwordx2 v[40:41], v6, s[52:55], s60 offen
    s_mov_b32 s60, 6912
    buffer_load_dwordx2 v[26:27], v6, s[44:47], s60 offen
    buffer_load_dwordx2 v[42:43], v6, s[52:55], s60 offen
    s_mov_b32 s60, 8064
    buffer_load_dwordx2 v[28:29], v6, s[44:47], s60 offen
    buffer_load_dwordx2 v[44:45], v6, s[52:55], s60 offen
    v_lshlrev_b32 v7, 3, v57
    buffer_load_dwordx4 v[48:51], v7, s[56:59], 0 offen
    buffer_load_dwordx4 v[52:55], v7, s[56:59], 0 offen offset:16
    s_cmp_lg_u32 s7, 3
    s_cbranch_scc1 L_p1a6
    s_mov_b64 exec, 0xffff
    v_add_u32 v6, 0x80, v1
    v_mul_u32_u24 v7, 3641, v6
    v_lshrrev_b32 v7, 16, v7
    s_lshl_b32 s60, s4, 6
    v_lshl_add_u32 v58, v7, 3, s60
    v_mul_u32_u24 v7, 18, v7
    v_sub_u32 v6, v6, v7
    s_mul_i32 s60, s5, 72
    v_lshl_add_u32 v59, v6, 2, s60
    v_mul_u32_u24 v6, 1152, v58
    v_lshl_add_u32 v6, v59, 1, v6
    v_subrev_u32 v7, 3456, v6
    buffer_load_dwordx2 v[120:121], v7, s[44:47], 0 offen
    v_subrev_u32 v7, 2304, v6
    buffer_load_dwordx2 v[122:123], v7, s[44:47], 0 offen
    v_subrev_u32 v7, 1152, v6
    buffer_load_dwordx2 v[124:125], v7, s[44:47], 0 offen
    s_mov_b32 s60, 0
    buffer_load_dwordx2 v[126:127], v6, s[44:47], s60 offen
    buffer_load_dwordx2 v[142:143], v6, s[52:55], s60 offen
    s_mov_b32 s60, 1152
    buffer_load_dwordx2 v[128:129], v6, s[44:47], s60 offen
    buffer_load_dwordx2 v[144:145], v6, s[52:55], s60 offen
    s_mov_b32 s60, 2304
    buffer_load_dwordx2 v[130:131], v6, s[44:47], s60 offen
    buffer_load_dwordx2 v[146:147], v6, s[52:55], s60 offen
    s_mov_b32 s60, 3456
    buffer_load_dwordx2 v[132:133], v6, s[44:47], s60 offen
    buffer_load_dwordx2 v[148:149], v6, s[52:55], s60 offen
    s_mov_b32 s60, 4608
    buffer_load_dwordx2 v[134:135], v6, s[44:47], s60 offen
    buffer_load_dwordx2 v[150:151], v6, s[52:55], s60 offen
    s_mov_b32 s60, 5760
    buffer_load_dwordx2 v[136:137], v6, s[44:47], s60 offen
    buffer_load_dwordx2 v[152:153], v6, s[52:55], s60 offen
    s_mov_b32 s60, 6912
    buffer_load_dwordx2 v[138:139], v6, s[44:47], s60 offen
    buffer_load_dwordx2 v[154:155], v6, s[52:55], s60 offen
    s_mov_b32 s60, 8064
    buffer_load_dwordx2 v[140:141], v6, s[44:47], s60 offen
    buffer_load_dwordx2 v[156:157], v6, s[52:55], s60 offen
    v_lshlrev_b32 v7, 3, v59
    buffer_load_dwordx4 v[160:163], v7, s[56:59], 0 offen
    buffer_load_dwordx4 v[164:167], v7, s[56:59], 0 offen offset:16
    s_mov_b64 exec, -1
L_p1a6:
    s_waitcnt vmcnt(0)
    v_sub_u32 v7, 2040, v56
    v_lshrrev_b32 v6, 5, v7
    v_lshlrev_b32 v6, 5, v6
    v_bfe_u32 v3, v7, 4, 1
    v_lshl_add_u32 v6, v3, 11, v6
    v_bfe_u32 v3, v7, 3, 1
    v_lshl_add_u32 v6, v3, 4, v6
    v_lshl_add_u32 v6, v57, 12, v6
    v_lshlrev_b32 v64, 16, v8
    v_and_b32 v65, 0xffff0000, v8
    v_lshlrev_b32 v66, 16, v10
    v_and_b32 v67, 0xffff0000, v10
    v_lshlrev_b32 v68, 16, v12
    v_and_b32 v69, 0xffff0000, v12
    v_lshlrev_b32 v70, 16, v14
    v_and_b32 v71, 0xffff0000, v14
    v_lshlrev_b32 v72, 16, v16
    v_and_b32 v73, 0xffff0000, v16
    v_lshlrev_b32 v74, 16, v18
    v_and_b32 v75, 0xffff0000, v18
    v_lshlrev_b32 v76, 16, v20
    v_and_b32 v77, 0xffff0000, v20
    v_lshlrev_b32 v78, 16, v22
    v_and_b32 v79, 0xffff0000, v22
    v_lshlrev_b32 v80, 16, v24
    v_and_b32 v81, 0xffff0000, v24
    v_lshlrev_b32 v82, 16, v26
    v_and_b32 v83, 0xffff0000, v26
    v_lshlrev_b32 v84, 16, v28
    v_and_b32 v85, 0xffff0000, v28
    v_lshlrev_b32 v88, 16, v48
    v_lshlrev_b32 v89, 16, v50
    v_and_b32 v90, 0xffff0000, v48
    v_and_b32 v91, 0xffff0000, v50
    v_lshlrev_b32 v92, 16, v49
    v_lshlrev_b32 v93, 16, v51
    v_and_b32 v94, 0xffff0000, v49
    v_and_b32 v95, 0xffff0000, v51
    v_pk_mul_f32 v[96:97], v[64:65], v[94:95]
    v_pk_fma_f32 v[96:97], v[66:67], v[92:93], v[96:97]
    v_pk_fma_f32 v[96:97], v[68:69], v[90:91], v[96:97]
    v_pk_fma_f32 v[96:97], v[70:71], v[88:89], v[96:97]
    v_lshlrev_b32 v112, 16, v30
    v_and_b32 v113, 0xffff0000, v30
    v_pk_mul_f32 v[96:97], v[96:97], v[112:113]
    v_pk_mul_f32 v[98:99], v[66:67], v[94:95]
    v_pk_fma_f32 v[98:99], v[68:69], v[92:93], v[98:99]
    v_pk_fma_f32 v[98:99], v[70:71], v[90:91], v[98:99]
    v_pk_fma_f32 v[98:99], v[72:73], v[88:89], v[98:99]
    v_lshlrev_b32 v112, 16, v32
    v_and_b32 v113, 0xffff0000, v32
    v_pk_mul_f32 v[98:99], v[98:99], v[112:113]
    v_pk_mul_f32 v[100:101], v[68:69], v[94:95]
    v_pk_fma_f32 v[100:101], v[70:71], v[92:93], v[100:101]
    v_pk_fma_f32 v[100:101], v[72:73], v[90:91], v[100:101]
    v_pk_fma_f32 v[100:101], v[74:75], v[88:89], v[100:101]
    v_lshlrev_b32 v112, 16, v34
    v_and_b32 v113, 0xffff0000, v34
    v_pk_mul_f32 v[100:101], v[100:101], v[112:113]
    v_pk_mul_f32 v[102:103], v[70:71], v[94:95]
    v_pk_fma_f32 v[102:103], v[72:73], v[92:93], v[102:103]
    v_pk_fma_f32 v[102:103], v[74:75], v[90:91], v[102:103]
    v_pk_fma_f32 v[102:103], v[76:77], v[88:89], v[102:103]
    v_lshlrev_b32 v112, 16, v36
    v_and_b32 v113, 0xffff0000, v36
    v_pk_mul_f32 v[102:103], v[102:103], v[112:113]
    v_pk_mul_f32 v[104:105], v[72:73], v[94:95]
    v_pk_fma_f32 v[104:105], v[74:75], v[92:93], v[104:105]
    v_pk_fma_f32 v[104:105], v[76:77], v[90:91], v[104:105]
    v_pk_fma_f32 v[104:105], v[78:79], v[88:89], v[104:105]
    v_lshlrev_b32 v112, 16, v38
    v_and_b32 v113, 0xffff0000, v38
    v_pk_mul_f32 v[104:105], v[104:105], v[112:113]
    v_pk_mul_f32 v[106:107], v[74:75], v[94:95]
    v_pk_fma_f32 v[106:107], v[76:77], v[92:93], v[106:107]
    v_pk_fma_f32 v[106:107], v[78:79], v[90:91], v[106:107]
    v_pk_fma_f32 v[106:107], v[80:81], v[88:89], v[106:107]
    v_lshlrev_b32 v112, 16, v40
    v_and_b32 v113, 0xffff0000, v40
    v_pk_mul_f32 v[106:107], v[106:107], v[112:113]
    v_pk_mul_f32 v[108:109], v[76:77], v[94:95]
    v_pk_fma_f32 v[108:109], v[78:79], v[92:93], v[108:109]
    v_pk_fma_f32 v[108:109], v[80:81], v[90:91], v[108:109]
    v_pk_fma_f32 v[108:109], v[82:83], v[88:89], v[108:109]
    v_lshlrev_b32 v112, 16, v42
    v_and_b32 v113, 0xffff0000, v42
    v_pk_mul_f32 v[108:109], v[108:109], v[112:113]
    v_pk_mul_f32 v[110:111], v[78:79], v[94:95]
    v_pk_fma_f32 v[110:111], v[80:81], v[92:93], v[110:111]
    v_pk_fma_f32 v[110:111], v[82:83], v[90:91], v[110:111]
    v_pk_fma_f32 v[110:111], v[84:85], v[88:89], v[110:111]
    v_lshlrev_b32 v112, 16, v44
    v_and_b32 v113, 0xffff0000, v44
    v_pk_mul_f32 v[110:111], v[110:111], v[112:113]
    v_cvt_pk_bf16_f32 v60, v110, v108
    v_cvt_pk_bf16_f32 v61, v106, v104
    v_cvt_pk_bf16_f32 v62, v102, v100
    v_cvt_pk_bf16_f32 v63, v98, v96
    s_mov_b32 s60, 1048576
    buffer_store_dwordx4 v[60:63], v6, s[36:39], s60 offen sc1
    v_cvt_pk_bf16_f32 v116, v111, v109
    v_cvt_pk_bf16_f32 v117, v107, v105
    v_cvt_pk_bf16_f32 v118, v103, v101
    v_cvt_pk_bf16_f32 v119, v99, v97
    s_mov_b32 s60, 1052672
    buffer_store_dwordx4 v[116:119], v6, s[36:39], s60 offen sc1
    v_lshlrev_b32 v64, 16, v9
    v_and_b32 v65, 0xffff0000, v9
    v_lshlrev_b32 v66, 16, v11
    v_and_b32 v67, 0xffff0000, v11
    v_lshlrev_b32 v68, 16, v13
    v_and_b32 v69, 0xffff0000, v13
    v_lshlrev_b32 v70, 16, v15
    v_and_b32 v71, 0xffff0000, v15
    v_lshlrev_b32 v72, 16, v17
    v_and_b32 v73, 0xffff0000, v17
    v_lshlrev_b32 v74, 16, v19
    v_and_b32 v75, 0xffff0000, v19
    v_lshlrev_b32 v76, 16, v21
    v_and_b32 v77, 0xffff0000, v21
    v_lshlrev_b32 v78, 16, v23
    v_and_b32 v79, 0xffff0000, v23
    v_lshlrev_b32 v80, 16, v25
    v_and_b32 v81, 0xffff0000, v25
    v_lshlrev_b32 v82, 16, v27
    v_and_b32 v83, 0xffff0000, v27
    v_lshlrev_b32 v84, 16, v29
    v_and_b32 v85, 0xffff0000, v29
    v_lshlrev_b32 v88, 16, v52
    v_lshlrev_b32 v89, 16, v54
    v_and_b32 v90, 0xffff0000, v52
    v_and_b32 v91, 0xffff0000, v54
    v_lshlrev_b32 v92, 16, v53
    v_lshlrev_b32 v93, 16, v55
    v_and_b32 v94, 0xffff0000, v53
    v_and_b32 v95, 0xffff0000, v55
    v_pk_mul_f32 v[96:97], v[64:65], v[94:95]
    v_pk_fma_f32 v[96:97], v[66:67], v[92:93], v[96:97]
    v_pk_fma_f32 v[96:97], v[68:69], v[90:91], v[96:97]
    v_pk_fma_f32 v[96:97], v[70:71], v[88:89], v[96:97]
    v_lshlrev_b32 v112, 16, v31
    v_and_b32 v113, 0xffff0000, v31
    v_pk_mul_f32 v[96:97], v[96:97], v[112:113]
    v_pk_mul_f32 v[98:99], v[66:67], v[94:95]
    v_pk_fma_f32 v[98:99], v[68:69], v[92:93], v[98:99]
    v_pk_fma_f32 v[98:99], v[70:71], v[90:91], v[98:99]
    v_pk_fma_f32 v[98:99], v[72:73], v[88:89], v[98:99]
    v_lshlrev_b32 v112, 16, v33
    v_and_b32 v113, 0xffff0000, v33
    v_pk_mul_f32 v[98:99], v[98:99], v[112:113]
    v_pk_mul_f32 v[100:101], v[68:69], v[94:95]
    v_pk_fma_f32 v[100:101], v[70:71], v[92:93], v[100:101]
    v_pk_fma_f32 v[100:101], v[72:73], v[90:91], v[100:101]
    v_pk_fma_f32 v[100:101], v[74:75], v[88:89], v[100:101]
    v_lshlrev_b32 v112, 16, v35
    v_and_b32 v113, 0xffff0000, v35
    v_pk_mul_f32 v[100:101], v[100:101], v[112:113]
    v_pk_mul_f32 v[102:103], v[70:71], v[94:95]
    v_pk_fma_f32 v[102:103], v[72:73], v[92:93], v[102:103]
    v_pk_fma_f32 v[102:103], v[74:75], v[90:91], v[102:103]
    v_pk_fma_f32 v[102:103], v[76:77], v[88:89], v[102:103]
    v_lshlrev_b32 v112, 16, v37
    v_and_b32 v113, 0xffff0000, v37
    v_pk_mul_f32 v[102:103], v[102:103], v[112:113]
    v_pk_mul_f32 v[104:105], v[72:73], v[94:95]
    v_pk_fma_f32 v[104:105], v[74:75], v[92:93], v[104:105]
    v_pk_fma_f32 v[104:105], v[76:77], v[90:91], v[104:105]
    v_pk_fma_f32 v[104:105], v[78:79], v[88:89], v[104:105]
    v_lshlrev_b32 v112, 16, v39
    v_and_b32 v113, 0xffff0000, v39
    v_pk_mul_f32 v[104:105], v[104:105], v[112:113]
    v_pk_mul_f32 v[106:107], v[74:75], v[94:95]
    v_pk_fma_f32 v[106:107], v[76:77], v[92:93], v[106:107]
    v_pk_fma_f32 v[106:107], v[78:79], v[90:91], v[106:107]
    v_pk_fma_f32 v[106:107], v[80:81], v[88:89], v[106:107]
    v_lshlrev_b32 v112, 16, v41
    v_and_b32 v113, 0xffff0000, v41
    v_pk_mul_f32 v[106:107], v[106:107], v[112:113]
    v_pk_mul_f32 v[108:109], v[76:77], v[94:95]
    v_pk_fma_f32 v[108:109], v[78:79], v[92:93], v[108:109]
    v_pk_fma_f32 v[108:109], v[80:81], v[90:91], v[108:109]
    v_pk_fma_f32 v[108:109], v[82:83], v[88:89], v[108:109]
    v_lshlrev_b32 v112, 16, v43
    v_and_b32 v113, 0xffff0000, v43
    v_pk_mul_f32 v[108:109], v[108:109], v[112:113]
    v_pk_mul_f32 v[110:111], v[78:79], v[94:95]
    v_pk_fma_f32 v[110:111], v[80:81], v[92:93], v[110:111]
    v_pk_fma_f32 v[110:111], v[82:83], v[90:91], v[110:111]
    v_pk_fma_f32 v[110:111], v[84:85], v[88:89], v[110:111]
    v_lshlrev_b32 v112, 16, v45
    v_and_b32 v113, 0xffff0000, v45
    v_pk_mul_f32 v[110:111], v[110:111], v[112:113]
    v_cvt_pk_bf16_f32 v60, v110, v108
    v_cvt_pk_bf16_f32 v61, v106, v104
    v_cvt_pk_bf16_f32 v62, v102, v100
    v_cvt_pk_bf16_f32 v63, v98, v96
    s_mov_b32 s60, 1056768
    buffer_store_dwordx4 v[60:63], v6, s[36:39], s60 offen sc1
    v_cvt_pk_bf16_f32 v116, v111, v109
    v_cvt_pk_bf16_f32 v117, v107, v105
    v_cvt_pk_bf16_f32 v118, v103, v101
    v_cvt_pk_bf16_f32 v119, v99, v97
    s_mov_b32 s60, 1060864
    buffer_store_dwordx4 v[116:119], v6, s[36:39], s60 offen sc1
    s_cmp_lg_u32 s7, 3
    s_cbranch_scc1 L_h_p1b
    s_mov_b64 exec, 0xffff
    v_sub_u32 v7, 2040, v58
    v_lshrrev_b32 v6, 5, v7
    v_lshlrev_b32 v6, 5, v6
    v_bfe_u32 v3, v7, 4, 1
    v_lshl_add_u32 v6, v3, 11, v6
    v_bfe_u32 v3, v7, 3, 1
    v_lshl_add_u32 v6, v3, 4, v6
    v_lshl_add_u32 v6, v59, 12, v6
    v_lshlrev_b32 v64, 16, v120
    v_and_b32 v65, 0xffff0000, v120
    v_lshlrev_b32 v66, 16, v122
    v_and_b32 v67, 0xffff0000, v122
    v_lshlrev_b32 v68, 16, v124
    v_and_b32 v69, 0xffff0000, v124
    v_lshlrev_b32 v70, 16, v126
    v_and_b32 v71, 0xffff0000, v126
    v_lshlrev_b32 v72, 16, v128
    v_and_b32 v73, 0xffff0000, v128
    v_lshlrev_b32 v74, 16, v130
    v_and_b32 v75, 0xffff0000, v130
    v_lshlrev_b32 v76, 16, v132
    v_and_b32 v77, 0xffff0000, v132
    v_lshlrev_b32 v78, 16, v134
    v_and_b32 v79, 0xffff0000, v134
    v_lshlrev_b32 v80, 16, v136
    v_and_b32 v81, 0xffff0000, v136
    v_lshlrev_b32 v82, 16, v138
    v_and_b32 v83, 0xffff0000, v138
    v_lshlrev_b32 v84, 16, v140
    v_and_b32 v85, 0xffff0000, v140
    v_lshlrev_b32 v88, 16, v160
    v_lshlrev_b32 v89, 16, v162
    v_and_b32 v90, 0xffff0000, v160
    v_and_b32 v91, 0xffff0000, v162
    v_lshlrev_b32 v92, 16, v161
    v_lshlrev_b32 v93, 16, v163
    v_and_b32 v94, 0xffff0000, v161
    v_and_b32 v95, 0xffff0000, v163
    v_pk_mul_f32 v[96:97], v[64:65], v[94:95]
    v_pk_fma_f32 v[96:97], v[66:67], v[92:93], v[96:97]
    v_pk_fma_f32 v[96:97], v[68:69], v[90:91], v[96:97]
    v_pk_fma_f32 v[96:97], v[70:71], v[88:89], v[96:97]
    v_lshlrev_b32 v112, 16, v142
    v_and_b32 v113, 0xffff0000, v142
    v_pk_mul_f32 v[96:97], v[96:97], v[112:113]
    v_pk_mul_f32 v[98:99], v[66:67], v[94:95]
    v_pk_fma_f32 v[98:99], v[68:69], v[92:93], v[98:99]
    v_pk_fma_f32 v[98:99], v[70:71], v[90:91], v[98:99]
    v_pk_fma_f32 v[98:99], v[72:73], v[88:89], v[98:99]
    v_lshlrev_b32 v112, 16, v144
    v_and_b32 v113, 0xffff0000, v144
    v_pk_mul_f32 v[98:99], v[98:99], v[112:113]
    v_pk_mul_f32 v[100:101], v[68:69], v[94:95]
    v_pk_fma_f32 v[100:101], v[70:71], v[92:93], v[100:101]
    v_pk_fma_f32 v[100:101], v[72:73], v[90:91], v[100:101]
    v_pk_fma_f32 v[100:101], v[74:75], v[88:89], v[100:101]
    v_lshlrev_b32 v112, 16, v146
    v_and_b32 v113, 0xffff0000, v146
    v_pk_mul_f32 v[100:101], v[100:101], v[112:113]
    v_pk_mul_f32 v[102:103], v[70:71], v[94:95]
    v_pk_fma_f32 v[102:103], v[72:73], v[92:93], v[102:103]
    v_pk_fma_f32 v[102:103], v[74:75], v[90:91], v[102:103]
    v_pk_fma_f32 v[102:103], v[76:77], v[88:89], v[102:103]
    v_lshlrev_b32 v112, 16, v148
    v_and_b32 v113, 0xffff0000, v148
    v_pk_mul_f32 v[102:103], v[102:103], v[112:113]
    v_pk_mul_f32 v[104:105], v[72:73], v[94:95]
    v_pk_fma_f32 v[104:105], v[74:75], v[92:93], v[104:105]
    v_pk_fma_f32 v[104:105], v[76:77], v[90:91], v[104:105]
    v_pk_fma_f32 v[104:105], v[78:79], v[88:89], v[104:105]
    v_lshlrev_b32 v112, 16, v150
    v_and_b32 v113, 0xffff0000, v150
    v_pk_mul_f32 v[104:105], v[104:105], v[112:113]
    v_pk_mul_f32 v[106:107], v[74:75], v[94:95]
    v_pk_fma_f32 v[106:107], v[76:77], v[92:93], v[106:107]
    v_pk_fma_f32 v[106:107], v[78:79], v[90:91], v[106:107]
    v_pk_fma_f32 v[106:107], v[80:81], v[88:89], v[106:107]
    v_lshlrev_b32 v112, 16, v152
    v_and_b32 v113, 0xffff0000, v152
    v_pk_mul_f32 v[106:107], v[106:107], v[112:113]
    v_pk_mul_f32 v[108:109], v[76:77], v[94:95]
    v_pk_fma_f32 v[108:109], v[78:79], v[92:93], v[108:109]
    v_pk_fma_f32 v[108:109], v[80:81], v[90:91], v[108:109]
    v_pk_fma_f32 v[108:109], v[82:83], v[88:89], v[108:109]
    v_lshlrev_b32 v112, 16, v154
    v_and_b32 v113, 0xffff0000, v154
    v_pk_mul_f32 v[108:109], v[108:109], v[112:113]
    v_pk_mul_f32 v[110:111], v[78:79], v[94:95]
    v_pk_fma_f32 v[110:111], v[80:81], v[92:93], v[110:111]
    v_pk_fma_f32 v[110:111], v[82:83], v[90:91], v[110:111]
    v_pk_fma_f32 v[110:111], v[84:85], v[88:89], v[110:111]
    v_lshlrev_b32 v112, 16, v156
    v_and_b32 v113, 0xffff0000, v156
    v_pk_mul_f32 v[110:111], v[110:111], v[112:113]
    v_cvt_pk_bf16_f32 v60, v110, v108
    v_cvt_pk_bf16_f32 v61, v106, v104
    v_cvt_pk_bf16_f32 v62, v102, v100
    v_cvt_pk_bf16_f32 v63, v98, v96
    s_mov_b32 s60, 1048576
    buffer_store_dwordx4 v[60:63], v6, s[36:39], s60 offen sc1
    v_cvt_pk_bf16_f32 v116, v111, v109
    v_cvt_pk_bf16_f32 v117, v107, v105
    v_cvt_pk_bf16_f32 v118, v103, v101
    v_cvt_pk_bf16_f32 v119, v99, v97
    s_mov_b32 s60, 1052672
    buffer_store_dwordx4 v[116:119], v6, s[36:39], s60 offen sc1
    v_lshlrev_b32 v64, 16, v121
    v_and_b32 v65, 0xffff0000, v121
    v_lshlrev_b32 v66, 16, v123
    v_and_b32 v67, 0xffff0000, v123
    v_lshlrev_b32 v68, 16, v125
    v_and_b32 v69, 0xffff0000, v125
    v_lshlrev_b32 v70, 16, v127
    v_and_b32 v71, 0xffff0000, v127
    v_lshlrev_b32 v72, 16, v129
    v_and_b32 v73, 0xffff0000, v129
    v_lshlrev_b32 v74, 16, v131
    v_and_b32 v75, 0xffff0000, v131
    v_lshlrev_b32 v76, 16, v133
    v_and_b32 v77, 0xffff0000, v133
    v_lshlrev_b32 v78, 16, v135
    v_and_b32 v79, 0xffff0000, v135
    v_lshlrev_b32 v80, 16, v137
    v_and_b32 v81, 0xffff0000, v137
    v_lshlrev_b32 v82, 16, v139
    v_and_b32 v83, 0xffff0000, v139
    v_lshlrev_b32 v84, 16, v141
    v_and_b32 v85, 0xffff0000, v141
    v_lshlrev_b32 v88, 16, v164
    v_lshlrev_b32 v89, 16, v166
    v_and_b32 v90, 0xffff0000, v164
    v_and_b32 v91, 0xffff0000, v166
    v_lshlrev_b32 v92, 16, v165
    v_lshlrev_b32 v93, 16, v167
    v_and_b32 v94, 0xffff0000, v165
    v_and_b32 v95, 0xffff0000, v167
    v_pk_mul_f32 v[96:97], v[64:65], v[94:95]
    v_pk_fma_f32 v[96:97], v[66:67], v[92:93], v[96:97]
    v_pk_fma_f32 v[96:97], v[68:69], v[90:91], v[96:97]
    v_pk_fma_f32 v[96:97], v[70:71], v[88:89], v[96:97]
    v_lshlrev_b32 v112, 16, v143
    v_and_b32 v113, 0xffff0000, v143
    v_pk_mul_f32 v[96:97], v[96:97], v[112:113]
    v_pk_mul_f32 v[98:99], v[66:67], v[94:95]
    v_pk_fma_f32 v[98:99], v[68:69], v[92:93], v[98:99]
    v_pk_fma_f32 v[98:99], v[70:71], v[90:91], v[98:99]
    v_pk_fma_f32 v[98:99], v[72:73], v[88:89], v[98:99]
    v_lshlrev_b32 v112, 16, v145
    v_and_b32 v113, 0xffff0000, v145
    v_pk_mul_f32 v[98:99], v[98:99], v[112:113]
    v_pk_mul_f32 v[100:101], v[68:69], v[94:95]
    v_pk_fma_f32 v[100:101], v[70:71], v[92:93], v[100:101]
    v_pk_fma_f32 v[100:101], v[72:73], v[90:91], v[100:101]
    v_pk_fma_f32 v[100:101], v[74:75], v[88:89], v[100:101]
    v_lshlrev_b32 v112, 16, v147
    v_and_b32 v113, 0xffff0000, v147
    v_pk_mul_f32 v[100:101], v[100:101], v[112:113]
    v_pk_mul_f32 v[102:103], v[70:71], v[94:95]
    v_pk_fma_f32 v[102:103], v[72:73], v[92:93], v[102:103]
    v_pk_fma_f32 v[102:103], v[74:75], v[90:91], v[102:103]
    v_pk_fma_f32 v[102:103], v[76:77], v[88:89], v[102:103]
    v_lshlrev_b32 v112, 16, v149
    v_and_b32 v113, 0xffff0000, v149
    v_pk_mul_f32 v[102:103], v[102:103], v[112:113]
    v_pk_mul_f32 v[104:105], v[72:73], v[94:95]
    v_pk_fma_f32 v[104:105], v[74:75], v[92:93], v[104:105]
    v_pk_fma_f32 v[104:105], v[76:77], v[90:91], v[104:105]
    v_pk_fma_f32 v[104:105], v[78:79], v[88:89], v[104:105]
    v_lshlrev_b32 v112, 16, v151
    v_and_b32 v113, 0xffff0000, v151
    v_pk_mul_f32 v[104:105], v[104:105], v[112:113]
    v_pk_mul_f32 v[106:107], v[74:75], v[94:95]
    v_pk_fma_f32 v[106:107], v[76:77], v[92:93], v[106:107]
    v_pk_fma_f32 v[106:107], v[78:79], v[90:91], v[106:107]
    v_pk_fma_f32 v[106:107], v[80:81], v[88:89], v[106:107]
    v_lshlrev_b32 v112, 16, v153
    v_and_b32 v113, 0xffff0000, v153
    v_pk_mul_f32 v[106:107], v[106:107], v[112:113]
    v_pk_mul_f32 v[108:109], v[76:77], v[94:95]
    v_pk_fma_f32 v[108:109], v[78:79], v[92:93], v[108:109]
    v_pk_fma_f32 v[108:109], v[80:81], v[90:91], v[108:109]
    v_pk_fma_f32 v[108:109], v[82:83], v[88:89], v[108:109]
    v_lshlrev_b32 v112, 16, v155
    v_and_b32 v113, 0xffff0000, v155
    v_pk_mul_f32 v[108:109], v[108:109], v[112:113]
    v_pk_mul_f32 v[110:111], v[78:79], v[94:95]
    v_pk_fma_f32 v[110:111], v[80:81], v[92:93], v[110:111]
    v_pk_fma_f32 v[110:111], v[82:83], v[90:91], v[110:111]
    v_pk_fma_f32 v[110:111], v[84:85], v[88:89], v[110:111]
    v_lshlrev_b32 v112, 16, v157
    v_and_b32 v113, 0xffff0000, v157
    v_pk_mul_f32 v[110:111], v[110:111], v[112:113]
    v_cvt_pk_bf16_f32 v60, v110, v108
    v_cvt_pk_bf16_f32 v61, v106, v104
    v_cvt_pk_bf16_f32 v62, v102, v100
    v_cvt_pk_bf16_f32 v63, v98, v96
    s_mov_b32 s60, 1056768
    buffer_store_dwordx4 v[60:63], v6, s[36:39], s60 offen sc1
    v_cvt_pk_bf16_f32 v116, v111, v109
    v_cvt_pk_bf16_f32 v117, v107, v105
    v_cvt_pk_bf16_f32 v118, v103, v101
    v_cvt_pk_bf16_f32 v119, v99, v97
    s_mov_b32 s60, 1060864
    buffer_store_dwordx4 v[116:119], v6, s[36:39], s60 offen sc1
    s_mov_b64 exec, -1
L_h_p1b:
    s_waitcnt vmcnt(0)
    v_mov_b32 v3, 157196
    v_mov_b32 v6, 1
    s_mov_b64 exec, 1
    ds_add_rtn_u32 v6, v3, v6
    s_waitcnt lgkmcnt(0)
    v_readfirstlane_b32 s60, v6
    s_mov_b64 exec, -1
    s_cmp_lg_u32 s60, 1
    s_cbranch_scc1 L_nl7
    v_mov_b32 v6, s6
    s_lshl_b32 s60, s2, 5
    s_add_u32 s60, s60, 327680
    v_mov_b32 v3, 0
    s_mov_b64 exec, 1
    buffer_store_dword v6, v3, s[36:39], s60 offen sc1
    s_mov_b64 exec, -1
L_nl7:
    s_branch L_h_epi
L_h_kv:
    v_lshrrev_b32 v6, 2, v4
    v_lshl_add_u32 v6, v5, 3, v6
    v_mul_u32_u24 v6, 48, v6
    v_and_b32 v7, 3, v4
    v_lshlrev_b32 v7, 3, v7
    s_cmp_eq_u32 s7, 1
    s_cselect_b64 s[64:65], -1, 0
    v_cndmask_b32 v7, v7, 32, s[64:65]
    v_add_u32 v14, v6, v7
    v_add_u32 v14, 128000, v14
    s_and_b32 s60, s5, 3
    s_lshl_b32 s60, s60, 4
    v_add_u32 v6, s60, v4
    v_bfe_u32 v7, v6, 1, 3
    v_mul_u32_u24 v3, 640, v6
    v_add_u32 v15, 0, v5
    v_xor_b32 v15, v15, v7
    v_lshl_add_u32 v8, v15, 4, v3
    v_add_u32 v15, 4, v5
    v_xor_b32 v15, v15, v7
    v_lshl_add_u32 v9, v15, 4, v3
    v_lshlrev_b32 v3, 9, v6
    v_add_u32 v15, 0, v5
    v_xor_b32 v15, v15, v4
    v_lshl_add_u32 v10, v15, 4, v3
    v_add_u32 v15, 4, v5
    v_xor_b32 v15, v15, v4
    v_lshl_add_u32 v11, v15, 4, v3
    v_add_u32 v15, 8, v5
    v_xor_b32 v15, v15, v4
    v_lshl_add_u32 v12, v15, 4, v3
    v_add_u32 v15, 12, v5
    v_xor_b32 v15, v15, v4
    v_lshl_add_u32 v13, v15, 4, v3
    s_lshl_b32 s60, s4, 1
    s_bfe_u32 s61, s5, 0x10001
    s_add_u32 s60, s60, s61
    s_mul_i32 s60, s60, 2320
    s_add_u32 s66, s60, 65536
    s_and_b32 s61, s5, 1
    s_cmp_ge_u32 s5, 4
    s_cbranch_scc1 L_h_av
    s_lshl_b32 s60, s61, 4
    v_add_u32 v6, s60, v4
    v_lshlrev_b32 v7, 4, v6
    v_lshl_add_u32 v16, v5, 3, v7
    v_add_u32 v17, 4, v16
    v_lshlrev_b32 v3, 2, v6
    v_add_u32 v3, 1024, v3
    v_add_u32 v15, 512, v7
    v_cmp_eq_u32 vcc, 2, v5
    s_nop 1
    v_cndmask_b32 v16, v16, v3, vcc
    v_cndmask_b32 v17, v17, v15, vcc
    v_add_u32 v3, 4, v15
    v_add_u32 v6, 8, v15
    v_cmp_eq_u32 vcc, 3, v5
    s_nop 1
    v_cndmask_b32 v16, v16, v3, vcc
    v_cndmask_b32 v17, v17, v6, vcc
    v_add_u32 v15, 12, v15
    v_cndmask_b32 v16, v16, v15, s[64:65]
    s_branch L_h_adone
L_h_av:
    s_mul_i32 s61, s61, 576
    s_lshl_b32 s60, s7, 8
    s_add_u32 s61, s61, s60
    v_lshrrev_b32 v6, 1, v5
    v_and_b32 v7, 1, v5
    v_mul_u32_u24 v7, 288, v7
    v_lshl_add_u32 v7, v6, 3, v7
    v_lshl_add_u32 v7, v4, 4, v7
    v_add_u32 v16, s61, v7
    v_add_u32 v16, 1152, v16
    v_lshlrev_b32 v6, 3, v6
    v_add_u32 v17, 2304, v6
L_h_adone:
    s_waitcnt vmcnt(0)
    v_readfirstlane_b32 s6, v2
    s_nop 0
    s_add_u32 s6, s6, 2654435769
    v_mov_b32 v3, 157184
    v_mov_b32 v6, 1
    s_mov_b64 exec, 1
    ds_add_u32 v3, v6 offset:16
    ds_add_u32 v3, v6
    s_mov_b64 exec, -1
    v_mov_b32 v3, 157184
    s_mov_b32 s89, 2097152
L_spin8:
    ds_read_b32 v6, v3
    s_waitcnt lgkmcnt(0)
    v_readfirstlane_b32 s88, v6
    s_nop 0
    s_cmp_ge_u32 s88, 4
    s_cbranch_scc1 L_spun9
    s_sleep 0
    s_sub_u32 s89, s89, 1
    s_cbranch_scc0 L_spin8
L_spun9:
    s_cmp_ge_u32 s5, 4
    s_cbranch_scc1 L_h_vproj
    ds_read_b64_tr_b16 v[64:65], v14 offset:0
    ds_read_b64_tr_b16 v[66:67], v14 offset:192
    ds_read_b128 v[96:99], v8 offset:0
    ds_read_b64_tr_b16 v[68:69], v14 offset:1536
    ds_read_b64_tr_b16 v[70:71], v14 offset:1728
    ds_read_b128 v[100:103], v9 offset:0
    ds_read_b64_tr_b16 v[72:73], v14 offset:3072
    ds_read_b64_tr_b16 v[74:75], v14 offset:3264
    ds_read_b128 v[104:107], v8 offset:128
    ds_read_b64_tr_b16 v[76:77], v14 offset:4608
    ds_read_b64_tr_b16 v[78:79], v14 offset:4800
    ds_read_b128 v[108:111], v9 offset:128
    ds_read_b64_tr_b16 v[80:81], v14 offset:6144
    ds_read_b64_tr_b16 v[82:83], v14 offset:6336
    ds_read_b128 v[112:115], v8 offset:256
    s_waitcnt lgkmcnt(12)
    v_mfma_f32_16x16x32_bf16 v[92:95], v[64:67], v[96:99], 0
    ds_read_b64_tr_b16 v[64:65], v14 offset:7680
    ds_read_b64_tr_b16 v[66:67], v14 offset:7872
    ds_read_b128 v[96:99], v9 offset:256
    s_waitcnt lgkmcnt(12)
    v_mfma_f32_16x16x32_bf16 v[92:95], v[68:71], v[100:103], v[92:95]
    ds_read_b64_tr_b16 v[68:69], v14 offset:9216
    ds_read_b64_tr_b16 v[70:71], v14 offset:9408
    ds_read_b128 v[100:103], v8 offset:384
    s_waitcnt lgkmcnt(12)
    v_mfma_f32_16x16x32_bf16 v[92:95], v[72:75], v[104:107], v[92:95]
    ds_read_b64_tr_b16 v[72:73], v14 offset:10752
    ds_read_b64_tr_b16 v[74:75], v14 offset:10944
    ds_read_b128 v[104:107], v9 offset:384
    s_waitcnt lgkmcnt(12)
    v_mfma_f32_16x16x32_bf16 v[92:95], v[76:79], v[108:111], v[92:95]
    ds_read_b64_tr_b16 v[76:77], v14 offset:12288
    ds_read_b64_tr_b16 v[78:79], v14 offset:12480
    ds_read_b128 v[108:111], v8 offset:512
    s_waitcnt lgkmcnt(12)
    v_mfma_f32_16x16x32_bf16 v[92:95], v[80:83], v[112:115], v[92:95]
    ds_read_b64_tr_b16 v[80:81], v14 offset:13824
    ds_read_b64_tr_b16 v[82:83], v14 offset:14016
    ds_read_b128 v[112:115], v9 offset:512
    s_waitcnt lgkmcnt(12)
    v_mfma_f32_16x16x32_bf16 v[92:95], v[64:67], v[96:99], v[92:95]
    ds_read_b64_tr_b16 v[64:65], v14 offset:15360
    ds_read_b64_tr_b16 v[66:67], v14 offset:15552
    ds_read_b128 v[96:99], v10 offset:40960
    s_waitcnt lgkmcnt(12)
    v_mfma_f32_16x16x32_bf16 v[92:95], v[68:71], v[100:103], v[92:95]
    ds_read_b64_tr_b16 v[68:69], v14 offset:16896
    ds_read_b64_tr_b16 v[70:71], v14 offset:17088
    ds_read_b128 v[100:103], v11 offset:40960
    s_waitcnt lgkmcnt(12)
    v_mfma_f32_16x16x32_bf16 v[92:95], v[72:75], v[104:107], v[92:95]
    ds_read_b64_tr_b16 v[72:73], v14 offset:18432
    ds_read_b64_tr_b16 v[74:75], v14 offset:18624
    ds_read_b128 v[104:107], v12 offset:40960
    s_waitcnt lgkmcnt(12)
    v_mfma_f32_16x16x32_bf16 v[92:95], v[76:79], v[108:111], v[92:95]
    ds_read_b64_tr_b16 v[76:77], v14 offset:19968
    ds_read_b64_tr_b16 v[78:79], v14 offset:20160
    ds_read_b128 v[108:111], v13 offset:40960
    s_waitcnt lgkmcnt(12)
    v_mfma_f32_16x16x32_bf16 v[92:95], v[80:83], v[112:115], v[92:95]
    ds_read_b64_tr_b16 v[80:81], v14 offset:21504
    ds_read_b64_tr_b16 v[82:83], v14 offset:21696
    ds_read_b128 v[112:115], v10 offset:41216
    s_waitcnt lgkmcnt(12)
    v_mfma_f32_16x16x32_bf16 v[92:95], v[64:67], v[96:99], v[92:95]
    ds_read_b64_tr_b16 v[64:65], v14 offset:23040
    ds_read_b64_tr_b16 v[66:67], v14 offset:23232
    ds_read_b128 v[96:99], v11 offset:41216
    s_waitcnt lgkmcnt(12)
    v_mfma_f32_16x16x32_bf16 v[92:95], v[68:71], v[100:103], v[92:95]
    ds_read_b64_tr_b16 v[68:69], v14 offset:24576
    ds_read_b64_tr_b16 v[70:71], v14 offset:24768
    ds_read_b128 v[100:103], v12 offset:41216
    s_waitcnt lgkmcnt(12)
    v_mfma_f32_16x16x32_bf16 v[92:95], v[72:75], v[104:107], v[92:95]
    ds_read_b64_tr_b16 v[72:73], v14 offset:26112
    ds_read_b64_tr_b16 v[74:75], v14 offset:26304
    ds_read_b128 v[104:107], v13 offset:41216
    s_waitcnt lgkmcnt(12)
    v_mfma_f32_16x16x32_bf16 v[92:95], v[76:79], v[108:111], v[92:95]
    s_waitcnt lgkmcnt(9)
    v_mfma_f32_16x16x32_bf16 v[92:95], v[80:83], v[112:115], v[92:95]
    s_waitcnt lgkmcnt(6)
    v_mfma_f32_16x16x32_bf16 v[92:95], v[64:67], v[96:99], v[92:95]
    s_waitcnt lgkmcnt(3)
    v_mfma_f32_16x16x32_bf16 v[92:95], v[68:71], v[100:103], v[92:95]
    s_waitcnt lgkmcnt(0)
    v_mfma_f32_16x16x32_bf16 v[92:95], v[72:75], v[104:107], v[92:95]
    s_nop 7
    v_cvt_pk_bf16_f32 v64, v92, v93
    v_cvt_pk_bf16_f32 v65, v94, v95
    v_mul_f32 v66, v92, v92
    v_fmac_f32 v66, v93, v93
    s_cmp_eq_u32 s7, 1
    s_cbranch_scc1 L_h_stk2
    buffer_store_dword v64, v16, s[36:39], s66 offen sc1
    buffer_store_dword v65, v17, s[36:39], s66 offen sc1
    v_fmac_f32 v66, v94, v94
    v_fmac_f32 v66, v95, v95
    v_mov_b32 v67, v66
    s_nop 1
    v_permlane32_swap_b32 v66, v67
    v_add_f32 v66, v66, v67
    v_mov_b32 v67, v66
    s_nop 1
    v_permlane16_swap_b32 v66, v67
    v_add_f32 v66, v66, v67
    v_mov_b32 v3, 157216
    s_branch L_h_stmax
L_h_stk2:
    s_mov_b64 exec, 0xffff
    buffer_store_dword v64, v16, s[36:39], s66 offen sc1
    s_mov_b64 exec, -1
    v_mov_b32 v3, 157220
L_h_stmax:
    v_max_f32_dpp v66, v66, v66 row_ror:8 row_mask:0xf bank_mask:0xf
    s_nop 1
    v_max_f32_dpp v66, v66, v66 row_ror:4 row_mask:0xf bank_mask:0xf
    s_nop 1
    v_max_f32_dpp v66, v66, v66 row_ror:2 row_mask:0xf bank_mask:0xf
    s_nop 1
    v_max_f32_dpp v66, v66, v66 row_ror:1 row_mask:0xf bank_mask:0xf
    ds_write_b32 v3, v66
    s_branch L_h_std
L_h_vproj:
    ds_read_b64_tr_b16 v[64:65], v14 offset:0
    ds_read_b64_tr_b16 v[66:67], v14 offset:192
    ds_read_b128 v[96:99], v8 offset:0
    ds_read_b64_tr_b16 v[68:69], v14 offset:1536
    ds_read_b64_tr_b16 v[70:71], v14 offset:1728
    ds_read_b128 v[100:103], v9 offset:0
    ds_read_b64_tr_b16 v[72:73], v14 offset:3072
    ds_read_b64_tr_b16 v[74:75], v14 offset:3264
    ds_read_b128 v[104:107], v8 offset:128
    ds_read_b64_tr_b16 v[76:77], v14 offset:4608
    ds_read_b64_tr_b16 v[78:79], v14 offset:4800
    ds_read_b128 v[108:111], v9 offset:128
    ds_read_b64_tr_b16 v[80:81], v14 offset:6144
    ds_read_b64_tr_b16 v[82:83], v14 offset:6336
    ds_read_b128 v[112:115], v8 offset:256
    s_waitcnt lgkmcnt(12)
    v_mfma_f32_16x16x32_bf16 v[92:95], v[96:99], v[64:67], 0
    ds_read_b64_tr_b16 v[64:65], v14 offset:7680
    ds_read_b64_tr_b16 v[66:67], v14 offset:7872
    ds_read_b128 v[96:99], v9 offset:256
    s_waitcnt lgkmcnt(12)
    v_mfma_f32_16x16x32_bf16 v[92:95], v[100:103], v[68:71], v[92:95]
    ds_read_b64_tr_b16 v[68:69], v14 offset:9216
    ds_read_b64_tr_b16 v[70:71], v14 offset:9408
    ds_read_b128 v[100:103], v8 offset:384
    s_waitcnt lgkmcnt(12)
    v_mfma_f32_16x16x32_bf16 v[92:95], v[104:107], v[72:75], v[92:95]
    ds_read_b64_tr_b16 v[72:73], v14 offset:10752
    ds_read_b64_tr_b16 v[74:75], v14 offset:10944
    ds_read_b128 v[104:107], v9 offset:384
    s_waitcnt lgkmcnt(12)
    v_mfma_f32_16x16x32_bf16 v[92:95], v[108:111], v[76:79], v[92:95]
    ds_read_b64_tr_b16 v[76:77], v14 offset:12288
    ds_read_b64_tr_b16 v[78:79], v14 offset:12480
    ds_read_b128 v[108:111], v8 offset:512
    s_waitcnt lgkmcnt(12)
    v_mfma_f32_16x16x32_bf16 v[92:95], v[112:115], v[80:83], v[92:95]
    ds_read_b64_tr_b16 v[80:81], v14 offset:13824
    ds_read_b64_tr_b16 v[82:83], v14 offset:14016
    ds_read_b128 v[112:115], v9 offset:512
    s_waitcnt lgkmcnt(12)
    v_mfma_f32_16x16x32_bf16 v[92:95], v[96:99], v[64:67], v[92:95]
    ds_read_b64_tr_b16 v[64:65], v14 offset:15360
    ds_read_b64_tr_b16 v[66:67], v14 offset:15552
    ds_read_b128 v[96:99], v10 offset:40960
    s_waitcnt lgkmcnt(12)
    v_mfma_f32_16x16x32_bf16 v[92:95], v[100:103], v[68:71], v[92:95]
    ds_read_b64_tr_b16 v[68:69], v14 offset:16896
    ds_read_b64_tr_b16 v[70:71], v14 offset:17088
    ds_read_b128 v[100:103], v11 offset:40960
    s_waitcnt lgkmcnt(12)
    v_mfma_f32_16x16x32_bf16 v[92:95], v[104:107], v[72:75], v[92:95]
    ds_read_b64_tr_b16 v[72:73], v14 offset:18432
    ds_read_b64_tr_b16 v[74:75], v14 offset:18624
    ds_read_b128 v[104:107], v12 offset:40960
    s_waitcnt lgkmcnt(12)
    v_mfma_f32_16x16x32_bf16 v[92:95], v[108:111], v[76:79], v[92:95]
    ds_read_b64_tr_b16 v[76:77], v14 offset:19968
    ds_read_b64_tr_b16 v[78:79], v14 offset:20160
    ds_read_b128 v[108:111], v13 offset:40960
    s_waitcnt lgkmcnt(12)
    v_mfma_f32_16x16x32_bf16 v[92:95], v[112:115], v[80:83], v[92:95]
    ds_read_b64_tr_b16 v[80:81], v14 offset:21504
    ds_read_b64_tr_b16 v[82:83], v14 offset:21696
    ds_read_b128 v[112:115], v10 offset:41216
    s_waitcnt lgkmcnt(12)
    v_mfma_f32_16x16x32_bf16 v[92:95], v[96:99], v[64:67], v[92:95]
    ds_read_b64_tr_b16 v[64:65], v14 offset:23040
    ds_read_b64_tr_b16 v[66:67], v14 offset:23232
    ds_read_b128 v[96:99], v11 offset:41216
    s_waitcnt lgkmcnt(12)
    v_mfma_f32_16x16x32_bf16 v[92:95], v[100:103], v[68:71], v[92:95]
    ds_read_b64_tr_b16 v[68:69], v14 offset:24576
    ds_read_b64_tr_b16 v[70:71], v14 offset:24768
    ds_read_b128 v[100:103], v12 offset:41216
    s_waitcnt lgkmcnt(12)
    v_mfma_f32_16x16x32_bf16 v[92:95], v[104:107], v[72:75], v[92:95]
    ds_read_b64_tr_b16 v[72:73], v14 offset:26112
    ds_read_b64_tr_b16 v[74:75], v14 offset:26304
    ds_read_b128 v[104:107], v13 offset:41216
    s_waitcnt lgkmcnt(12)
    v_mfma_f32_16x16x32_bf16 v[92:95], v[108:111], v[76:79], v[92:95]
    s_waitcnt lgkmcnt(9)
    v_mfma_f32_16x16x32_bf16 v[92:95], v[112:115], v[80:83], v[92:95]
    s_waitcnt lgkmcnt(6)
    v_mfma_f32_16x16x32_bf16 v[92:95], v[96:99], v[64:67], v[92:95]
    s_waitcnt lgkmcnt(3)
    v_mfma_f32_16x16x32_bf16 v[92:95], v[100:103], v[68:71], v[92:95]
    s_waitcnt lgkmcnt(0)
    v_mfma_f32_16x16x32_bf16 v[92:95], v[104:107], v[72:75], v[92:95]
    s_nop 7
    v_cvt_pk_bf16_f32 v64, v92, v93
    v_cvt_pk_bf16_f32 v65, v94, v95
    s_cmp_eq_u32 s7, 0
    s_cbranch_scc1 L_h_stv
    v_mov_b32 v3, 0x3f803f80
    v_cmp_eq_u32 vcc, 2, v4
    s_nop 1
    v_cndmask_b32 v16, v16, v17, vcc
    v_cndmask_b32 v64, v64, v3, vcc
    v_cndmask_b32 v65, v65, v3, vcc
    v_cmp_gt_u32 vcc, 3, v4
    s_nop 0
    s_mov_b64 exec, vcc
L_h_stv:
    buffer_store_dwordx2 v[64:65], v16, s[36:39], s66 offen sc1
    s_mov_b64 exec, -1
L_h_std:
    v_mov_b32 v3, 157188
    v_mov_b32 v6, 1
    s_mov_b64 exec, 1
    ds_add_u32 v3, v6
    s_mov_b64 exec, -1
    s_waitcnt vmcnt(0)
    v_mov_b32 v3, 157192
    v_mov_b32 v6, 1
    s_mov_b64 exec, 1
    ds_add_rtn_u32 v6, v3, v6
    s_waitcnt lgkmcnt(0)
    v_readfirstlane_b32 s60, v6
    s_mov_b64 exec, -1
    s_cmp_lg_u32 s60, 3
    s_cbranch_scc1 L_nl10
    v_mov_b32 v3, 157216
    ds_read_b64 v[6:7], v3
    s_lshl_b32 s60, s2, 5
    s_add_u32 s60, s60, 262144
    v_mov_b32 v3, 0
    s_waitcnt lgkmcnt(0)
    v_add_f32 v7, v6, v7
    v_mov_b32 v6, s6
    s_mov_b64 exec, 1
    buffer_store_dwordx2 v[6:7], v3, s[36:39], s60 offen sc1
    s_mov_b64 exec, -1
L_nl10:
    s_cmp_lg_u32 s7, 0
    s_cbranch_scc1 L_h_wait
    v_mov_b32 v3, 157200
    s_mov_b32 s89, 2097152
L_spin11:
    ds_read_b32 v6, v3
    s_waitcnt lgkmcnt(0)
    v_readfirstlane_b32 s88, v6
    s_nop 0
    s_cmp_ge_u32 s88, 12
    s_cbranch_scc1 L_spun12
    s_sleep 2
    s_sub_u32 s89, s89, 1
    s_cbranch_scc0 L_spin11
L_spun12:
    v_lshlrev_b32 v3, 5, v1
    s_mov_b32 s60, 262144
    s_mov_b32 s61, 266240
    s_mov_b32 s62, 2097152
L_poll13:
    buffer_load_dwordx2 v[8:9], v3, s[36:39], s60 offen offset:0 sc1
    buffer_load_dwordx2 v[10:11], v3, s[36:39], s60 offen offset:2048 sc1
    buffer_load_dwordx2 v[12:13], v3, s[36:39], s61 offen offset:0 sc1
    buffer_load_dwordx2 v[14:15], v3, s[36:39], s61 offen offset:2048 sc1
    s_waitcnt vmcnt(0)
    v_cmp_ne_u32 vcc, s6, v8
    v_cmp_ne_u32 s[64:65], s6, v10
    s_nop 0
    s_or_b64 vcc, vcc, s[64:65]
    v_cmp_ne_u32 s[64:65], s6, v12
    s_nop 0
    s_or_b64 vcc, vcc, s[64:65]
    v_cmp_ne_u32 s[64:65], s6, v14
    s_nop 0
    s_or_b64 vcc, vcc, s[64:65]
    s_sub_u32 s62, s62, 1
    s_cbranch_scc1 L_polled14
    s_cbranch_vccz L_polled14
    s_sleep 6
    s_branch L_poll13
L_polled14:
    v_mov_b32 v3, 157232
    v_mov_b32 v6, 1
    s_mov_b64 exec, 1
    ds_add_u32 v3, v6
    s_mov_b64 exec, -1
    s_branch L_h_go
L_h_wait:
    v_mov_b32 v3, 157232
    s_mov_b32 s89, 2097152
L_spin15:
    ds_read_b32 v6, v3
    s_waitcnt lgkmcnt(0)
    v_readfirstlane_b32 s88, v6
    s_nop 0
    s_cmp_ge_u32 s88, 1
    s_cbranch_scc1 L_spun16
    s_sleep 2
    s_sub_u32 s89, s89, 1
    s_cbranch_scc0 L_spin15
L_spun16:
L_h_go:
    s_cmp_lg_u32 s7, 0
    s_cbranch_scc1 L_h_nokc
    v_max_f32 v9, v9, v11
    v_max3_f32 v9, v9, v13, v15
    s_nop 1
    v_max_f32_dpp v9, v9, v9 row_ror:8 row_mask:0xf bank_mask:0xf
    s_nop 1
    v_max_f32_dpp v9, v9, v9 row_ror:4 row_mask:0xf bank_mask:0xf
    s_nop 1
    v_max_f32_dpp v9, v9, v9 row_ror:2 row_mask:0xf bank_mask:0xf
    s_nop 1
    v_max_f32_dpp v9, v9, v9 row_ror:1 row_mask:0xf bank_mask:0xf
    v_mov_b32 v13, v9
    s_nop 1
    v_permlane16_swap_b32 v9, v13
    v_max_f32 v9, v9, v13
    v_mov_b32 v13, v9
    s_nop 1
    v_permlane32_swap_b32 v9, v13
    v_max_f32 v9, v9, v13
    v_sqrt_f32 v9, v9
    v_mov_b32 v10, 1.0
    v_mov_b32 v3, 157224
    v_mul_f32 v9, 1065520988, v9
    v_cvt_pk_bf16_f32 v10, v9, v10
    v_mov_b32 v11, s6
    ds_write_b64 v3, v[10:11]
    s_cmp_lg_u32 s2, 0
    s_cbranch_scc1 L_h_nokc
    v_mov_b32 v3, 0
    v_mov_b32 v6, s6
    s_mov_b64 exec, 1
    buffer_store_dword v6, v3, s[36:39], 0 offen sc1
    s_mov_b64 exec, -1
L_h_nokc:
    v_lshlrev_b32 v4, 4, v1
    v_mov_b32 v3, 157272
    s_mov_b32 s89, 2097152
L_spin17:
    ds_read_b32 v6, v3
    s_waitcnt lgkmcnt(0)
    v_readfirstlane_b32 s88, v6
    s_nop 0
    s_cmp_ge_u32 s88, 8
    s_cbranch_scc1 L_spun18
    s_sleep 0
    s_sub_u32 s89, s89, 1
    s_cbranch_scc0 L_spin17
L_spun18:
    s_lshl_b32 s60, s7, 10
    s_add_u32 s60, s60, 0
L_kvdma19:
    s_mov_b32 m0, s60
    s_add_u32 s61, s60, 65536
    s_add_u32 s60, s60, 2048
    buffer_load_dwordx4 v4, s[36:39], s61 offen sc1 lds
    s_cmp_lt_u32 s60, 40960
    s_cbranch_scc1 L_kvdma19
    v_mov_b32 v3, 157276
    v_mov_b32 v6, 1
    s_mov_b64 exec, 1
    ds_add_u32 v3, v6
    s_mov_b64 exec, -1
    s_waitcnt vmcnt(0)
    v_mov_b32 v3, 157248
    v_mov_b32 v6, 1
    s_mov_b64 exec, 1
    ds_add_u32 v3, v6
    s_mov_b64 exec, -1
    v_mov_b32 v3, 157244
    s_mov_b32 s89, 2097152
L_spin20:
    ds_read_b32 v6, v3
    s_waitcnt lgkmcnt(0)
    v_readfirstlane_b32 s88, v6
    s_nop 0
    s_cmp_ge_u32 s88, 8
    s_cbranch_scc1 L_spun21
    s_sleep 1
    s_sub_u32 s89, s89, 1
    s_cbranch_scc0 L_spin20
L_spun21:
    s_lshl_b32 s60, s7, 10
    s_add_u32 s60, s60, 40960
L_kvdma22:
    s_mov_b32 m0, s60
    s_add_u32 s61, s60, 65536
    s_add_u32 s60, s60, 2048
    buffer_load_dwordx4 v4, s[36:39], s61 offen sc1 lds
    s_cmp_lt_u32 s60, 148480
    s_cbranch_scc1 L_kvdma22
    s_waitcnt vmcnt(0)
    v_mov_b32 v3, 157208
    v_mov_b32 v6, 1
    s_mov_b64 exec, 1
    ds_add_u32 v3, v6
    s_mov_b64 exec, -1
    v_and_b32 v4, 15, v1
    v_lshrrev_b32 v5, 4, v1
    s_lshl_b32 s60, s4, 2
    s_lshl_b32 s61, s7, 1
    s_add_u32 s60, s60, s61
    s_mul_i32 s60, s60, 18432
    s_lshl_b32 s61, s5, 11
    s_add_u32 s60, s60, s61
    s_add_u32 s60, s60, 7340032
    v_lshlrev_b32 v6, 4, v1
    v_mov_b32 v8, -1
    v_mov_b32 v9, -1
    v_mov_b32 v10, -1
    v_mov_b32 v11, -1
    buffer_store_dwordx4 v[8:11], v6, s[36:39], s60 offen sc1
    buffer_store_dwordx4 v[8:11], v6, s[36:39], s60 offen offset:1024 sc1
    s_add_u32 s60, s60, 18432
    buffer_store_dwordx4 v[8:11], v6, s[36:39], s60 offen sc1
    buffer_store_dwordx4 v[8:11], v6, s[36:39], s60 offen offset:1024 sc1
    s_mul_i32 s60, s4, 73728
    s_lshl_b32 s61, s5, 8
    s_add_u32 s60, s60, s61
    s_add_u32 s60, s60, 7356416
    v_mul_u32_u24 v6, 18432, v5
    v_lshl_add_u32 v6, v4, 4, v6
    buffer_store_dwordx4 v[8:11], v6, s[36:39], s60 offen sc1
    v_lshlrev_b32 v6, 4, v1
    s_and_b32 s60, s7, 1
    s_lshl_b32 s60, s60, 10
    v_add_u32 v6, s60, v6
    v_mov_b32 v60, -1
    v_mov_b32 v61, -1
    v_mov_b32 v62, -1
    v_mov_b32 v63, -1
    s_mov_b32 s63, s2
L_h_ym:
    s_cmp_ge_u32 s63, 576
    s_cselect_b32 s61, 9177088, 0
    s_cmp_ge_u32 s63, 1152
    s_cselect_b32 s61, -522240, s61
    s_cmp_lt_u32 s63, 576
    s_cselect_b32 s61, 4194304, s61
    s_lshl_b32 s60, s63, 12
    s_add_u32 s60, s60, s61
    s_add_u32 s63, s63, 256
    buffer_store_dwordx4 v[60:63], v6, s[36:39], s60 offen sc1
    s_cmp_lt_u32 s63, 1728
    s_cbranch_scc1 L_h_ym
    s_waitcnt vmcnt(0)
    v_mov_b32 v3, 157284
    v_mov_b32 v6, 1
    s_mov_b64 exec, 1
    ds_add_rtn_u32 v6, v3, v6
    s_waitcnt lgkmcnt(0)
    v_readfirstlane_b32 s60, v6
    s_mov_b64 exec, -1
    s_cmp_lg_u32 s60, 1
    s_cbranch_scc1 L_h_nmk
    v_mov_b32 v6, s6
    s_lshl_b32 s60, s2, 5
    s_add_u32 s60, s60, 393216
    v_mov_b32 v3, 0
    s_mov_b64 exec, 1
    buffer_store_dword v6, v3, s[36:39], s60 offen sc1
    s_mov_b64 exec, -1
L_h_nmk:
    s_cmp_lg_u32 s7, 0
    s_cbranch_scc1 L_h_epi
    s_mov_b32 s40, s16
    s_mov_b32 s41, s17
    s_mov_b32 s42, 663552
    s_mov_b32 s43, 0x00020000
    v_lshlrev_b32 v4, 7, v1
    s_lshr_b32 s60, s2, 3
    s_mul_i32 s60, s60, 20736
    buffer_load_dword v8, v4, s[40:43], s60 offen
    s_add_u32 s60, s60, 8192
    buffer_load_dword v9, v4, s[40:43], s60 offen
    s_add_u32 s60, s60, 8192
    s_mov_b32 exec_hi, 3
    buffer_load_dword v10, v4, s[40:43], s60 offen
    s_mov_b64 exec, -1
    s_branch L_h_end
L_h_epi:
    s_sub_u32 s70, 3, s7
    s_lshl_b32 s70, s70, 6
    s_mov_b32 s40, s18
    s_mov_b32 s41, s19
    s_mov_b32 s42, 2359296
    s_mov_b32 s43, 0x00020000
    s_mov_b32 s48, s30
    s_mov_b32 s49, s31
    s_mov_b32 s50, 4718592
    s_mov_b32 s51, 0x00020000
    s_mov_b32 s52, s34
    s_mov_b32 s53, s35
    s_mov_b32 s54, 16777216
    s_mov_b32 s55, 0x00020000
    s_cmp_ge_u32 s4, 16
    s_cselect_b32 s54, s54, 0
    v_mov_b32 v3, 157208
    s_mov_b32 s89, 2097152
L_spin23:
    ds_read_b32 v6, v3
    s_waitcnt lgkmcnt(0)
    v_readfirstlane_b32 s88, v6
    s_nop 0
    s_cmp_ge_u32 s88, 2
    s_cbranch_scc1 L_spun24
    s_sleep 8
    s_sub_u32 s89, s89, 1
    s_cbranch_scc0 L_spin23
L_spun24:
    v_add_u32 v6, s70, v1
    v_and_b32 v7, 7, v6
    s_lshl_b32 s60, s4, 6
    v_lshl_add_u32 v56, v7, 3, s60
    v_lshrrev_b32 v6, 3, v6
    s_mul_i32 s60, s5, 72
    v_lshl_add_u32 v57, v6, 2, s60
    s_cmp_eq_u32 s7, 1
    s_cselect_b64 s[66:67], 0xffff, -1
    s_mov_b64 exec, s[66:67]
    v_lshlrev_b32 v7, 1, v57
    v_mul_u32_u24 v6, 1152, v56
    v_add_u32 v6, v6, v7
    s_mov_b32 s60, 0
    buffer_load_dwordx2 v[112:113], v6, s[40:43], s60 offen
    s_mov_b32 s60, 1152
    buffer_load_dwordx2 v[114:115], v6, s[40:43], s60 offen
    s_mov_b32 s60, 2304
    buffer_load_dwordx2 v[116:117], v6, s[40:43], s60 offen
    s_mov_b32 s60, 3456
    buffer_load_dwordx2 v[118:119], v6, s[40:43], s60 offen
    s_mov_b32 s60, 4608
    buffer_load_dwordx2 v[120:121], v6, s[40:43], s60 offen
    s_mov_b32 s60, 5760
    buffer_load_dwordx2 v[122:123], v6, s[40:43], s60 offen
    s_mov_b32 s60, 6912
    buffer_load_dwordx2 v[124:125], v6, s[40:43], s60 offen
    s_mov_b32 s60, 8064
    buffer_load_dwordx2 v[126:127], v6, s[40:43], s60 offen
    s_cmp_eq_u32 s7, 2
    s_cselect_b32 s60, 8960, 0
    s_cmp_eq_u32 s7, 1
    s_cselect_b32 s60, 4352, s60
    s_add_u32 s60, s60, 148480
    v_and_b32 v59, 7, v1
    v_mul_u32_u24 v59, 528, v59
    v_lshrrev_b32 v58, 3, v1
    v_lshl_add_u32 v59, v58, 3, v59
    v_add_u32 v59, s60, v59
    s_mov_b64 exec, -1
    s_cmp_eq_u32 s7, 1
    s_cselect_b32 s61, 0, 2
    v_lshrrev_b32 v58, s61, v1
    v_lshrrev_b32 v61, 3, v58
    v_lshlrev_b32 v61, 4, v61
    v_lshl_add_u32 v61, v58, 6, v61
    s_cselect_b32 s61, 0, 3
    v_and_b32 v62, s61, v1
    v_lshl_add_u32 v61, v62, 4, v61
    v_add_u32 v61, s60, v61
    v_mul_u32_u24 v58, 2304, v58
    v_lshl_add_u32 v58, v62, 4, v58
    s_mul_i32 s71, s4, 147456
    s_mul_i32 s60, s5, 144
    s_add_u32 s71, s71, s60
    s_add_u32 s71, s71, s70
    s_add_u32 s71, s71, 1152
    s_mov_b64 exec, s[66:67]
    v_lshlrev_b32 v60, 1, v56
    v_lshl_add_u32 v60, v57, 12, v60
    s_mov_b64 exec, -1
    s_cmp_lg_u32 s7, 3
    s_cbranch_scc1 L_e_n3
    v_mov_b32 v3, 157268
    s_mov_b32 s89, 2097152
L_spin25:
    ds_read_b32 v6, v3
    s_waitcnt lgkmcnt(0)
    v_readfirstlane_b32 s88, v6
    s_nop 0
    s_cmp_ge_u32 s88, 1
    s_cbranch_scc1 L_spun26
    s_sleep 8
    s_sub_u32 s89, s89, 1
    s_cbranch_scc0 L_spin25
L_spun26:
    v_lshlrev_b32 v3, 5, v1
    s_mov_b32 s60, 327680
    s_mov_b32 s61, 331776
    s_mov_b32 s62, 2097152
L_poll27:
    buffer_load_dwordx2 v[8:9], v3, s[36:39], s60 offen offset:0 sc1
    buffer_load_dwordx2 v[10:11], v3, s[36:39], s60 offen offset:2048 sc1
    buffer_load_dwordx2 v[12:13], v3, s[36:39], s61 offen offset:0 sc1
    buffer_load_dwordx2 v[14:15], v3, s[36:39], s61 offen offset:2048 sc1
    s_waitcnt vmcnt(0)
    v_cmp_ne_u32 vcc, s6, v8
    v_cmp_ne_u32 s[64:65], s6, v10
    s_nop 0
    s_or_b64 vcc, vcc, s[64:65]
    v_cmp_ne_u32 s[64:65], s6, v12
    s_nop 0
    s_or_b64 vcc, vcc, s[64:65]
    v_cmp_ne_u32 s[64:65], s6, v14
    s_nop 0
    s_or_b64 vcc, vcc, s[64:65]
    s_sub_u32 s62, s62, 1
    s_cbranch_scc1 L_polled28
    s_cbranch_vccz L_polled28
    s_sleep 8
    s_branch L_poll27
L_polled28:
    v_mov_b32 v3, 157252
    v_mov_b32 v6, 1
    s_mov_b64 exec, 1
    ds_add_u32 v3, v6
    s_mov_b64 exec, -1
    v_mov_b32 v3, 157284
    s_mov_b32 s89, 2097152
L_spin29:
    ds_read_b32 v6, v3
    s_waitcnt lgkmcnt(0)
    v_readfirstlane_b32 s88, v6
    s_nop 0
    s_cmp_ge_u32 s88, 2
    s_cbranch_scc1 L_spun30
    s_sleep 16
    s_sub_u32 s89, s89, 1
    s_cbranch_scc0 L_spin29
L_spun30:
    s_sleep 64
    v_lshlrev_b32 v3, 5, v1
    s_mov_b32 s60, 393216
    s_mov_b32 s61, 397312
    s_mov_b32 s62, 2097152
L_poll31:
    buffer_load_dwordx2 v[8:9], v3, s[36:39], s60 offen offset:0 sc1
    buffer_load_dwordx2 v[10:11], v3, s[36:39], s60 offen offset:2048 sc1
    buffer_load_dwordx2 v[12:13], v3, s[36:39], s61 offen offset:0 sc1
    buffer_load_dwordx2 v[14:15], v3, s[36:39], s61 offen offset:2048 sc1
    s_waitcnt vmcnt(0)
    v_cmp_ne_u32 vcc, s6, v8
    v_cmp_ne_u32 s[64:65], s6, v10
    s_nop 0
    s_or_b64 vcc, vcc, s[64:65]
    v_cmp_ne_u32 s[64:65], s6, v12
    s_nop 0
    s_or_b64 vcc, vcc, s[64:65]
    v_cmp_ne_u32 s[64:65], s6, v14
    s_nop 0
    s_or_b64 vcc, vcc, s[64:65]
    s_sub_u32 s62, s62, 1
    s_cbranch_scc1 L_polled32
    s_cbranch_vccz L_polled32
    s_sleep 8
    s_branch L_poll31
L_polled32:
    v_mov_b32 v3, 157288
    v_mov_b32 v6, 1
    s_mov_b64 exec, 1
    ds_add_u32 v3, v6
    s_mov_b64 exec, -1
    s_mov_b32 s40, s16
    s_mov_b32 s41, s17
    s_mov_b32 s42, 663552
    s_mov_b32 s43, 0x00020000
    v_add_u32 v5, 0, v1
    v_mul_u32_u24 v6, 7282, v5
    v_lshrrev_b32 v6, 16, v6
    v_mul_u32_u24 v7, 1008, v6
    v_lshl_add_u32 v16, v5, 4, v7
    v_add_u32 v5, 64, v1
    v_mul_u32_u24 v6, 7282, v5
    v_lshrrev_b32 v6, 16, v6
    v_mul_u32_u24 v7, 1008, v6
    v_lshl_add_u32 v17, v5, 4, v7
    v_add_u32 v5, 128, v1
    v_mul_u32_u24 v6, 7282, v5
    v_lshrrev_b32 v6, 16, v6
    v_mul_u32_u24 v7, 1008, v6
    v_lshl_add_u32 v18, v5, 4, v7
    v_add_u32 v5, 192, v1
    v_mul_u32_u24 v6, 7282, v5
    v_lshrrev_b32 v6, 16, v6
    v_mul_u32_u24 v7, 1008, v6
    v_lshl_add_u32 v19, v5, 4, v7
    v_add_u32 v5, 256, v1
    v_mul_u32_u24 v6, 7282, v5
    v_lshrrev_b32 v6, 16, v6
    v_mul_u32_u24 v7, 1008, v6
    v_lshl_add_u32 v20, v5, 4, v7
    v_add_u32 v5, 320, v1
    v_mul_u32_u24 v6, 7282, v5
    v_lshrrev_b32 v6, 16, v6
    v_mul_u32_u24 v7, 1008, v6
    v_lshl_add_u32 v21, v5, 4, v7
    v_add_u32 v5, 384, v1
    v_mul_u32_u24 v6, 7282, v5
    v_lshrrev_b32 v6, 16, v6
    v_mul_u32_u24 v7, 1008, v6
    v_lshl_add_u32 v22, v5, 4, v7
    v_add_u32 v5, 448, v1
    v_mul_u32_u24 v6, 7282, v5
    v_lshrrev_b32 v6, 16, v6
    v_mul_u32_u24 v7, 1008, v6
    v_lshl_add_u32 v23, v5, 4, v7
    v_add_u32 v5, 512, v1
    v_mul_u32_u24 v6, 7282, v5
    v_lshrrev_b32 v6, 16, v6
    v_mul_u32_u24 v7, 1008, v6
    v_lshl_add_u32 v24, v5, 4, v7
    s_mul_i32 s63, s5, 144
    s_mov_b32 s60, 0
    v_mov_b32 v3, 157212
    s_mov_b32 s89, 2097152
L_spin33:
    ds_read_b32 v6, v3
    s_waitcnt lgkmcnt(0)
    v_readfirstlane_b32 s88, v6
    s_nop 0
    s_cmp_ge_u32 s88, 8
    s_cbranch_scc1 L_spun34
    s_sleep 8
    s_sub_u32 s89, s89, 1
    s_cbranch_scc0 L_spin33
L_spun34:
L_wo0:
    s_add_u32 m0, s60, 32512
    s_nop 0
    buffer_load_dwordx4 v16, s[40:43], s63 offen lds
    s_add_u32 m0, s60, 33536
    s_nop 0
    buffer_load_dwordx4 v17, s[40:43], s63 offen lds
    s_add_u32 m0, s60, 34560
    s_nop 0
    buffer_load_dwordx4 v18, s[40:43], s63 offen lds
    s_add_u32 m0, s60, 35584
    s_nop 0
    buffer_load_dwordx4 v19, s[40:43], s63 offen lds
    s_add_u32 m0, s60, 36608
    s_nop 0
    buffer_load_dwordx4 v20, s[40:43], s63 offen lds
    s_add_u32 m0, s60, 37632
    s_nop 0
    buffer_load_dwordx4 v21, s[40:43], s63 offen lds
    s_add_u32 m0, s60, 38656
    s_nop 0
    buffer_load_dwordx4 v22, s[40:43], s63 offen lds
    s_add_u32 m0, s60, 39680
    s_nop 0
    buffer_load_dwordx4 v23, s[40:43], s63 offen lds
    s_add_u32 m0, s60, 40704
    s_nop 0
    buffer_load_dwordx4 v24, s[40:43], s63 offen lds
    s_add_u32 s60, s60, 9216
    s_add_u32 s63, s63, 73728
    s_cmp_lt_u32 s60, 55296
    s_cbranch_scc1 L_wo0
    v_mov_b32 v3, 157296
    s_mov_b32 s89, 2097152
L_spin35:
    ds_read_b32 v6, v3
    s_waitcnt lgkmcnt(0)
    v_readfirstlane_b32 s88, v6
    s_nop 0
    s_cmp_ge_u32 s88, 8
    s_cbranch_scc1 L_spun36
    s_sleep 8
    s_sub_u32 s89, s89, 1
    s_cbranch_scc0 L_spin35
L_spun36:
L_wo1:
    s_add_u32 m0, s60, 32512
    s_nop 0
    buffer_load_dwordx4 v16, s[40:43], s63 offen lds
    s_add_u32 m0, s60, 33536
    s_nop 0
    buffer_load_dwordx4 v17, s[40:43], s63 offen lds
    s_add_u32 m0, s60, 34560
    s_nop 0
    buffer_load_dwordx4 v18, s[40:43], s63 offen lds
    s_add_u32 m0, s60, 35584
    s_nop 0
    buffer_load_dwordx4 v19, s[40:43], s63 offen lds
    s_add_u32 m0, s60, 36608
    s_nop 0
    buffer_load_dwordx4 v20, s[40:43], s63 offen lds
    s_add_u32 m0, s60, 37632
    s_nop 0
    buffer_load_dwordx4 v21, s[40:43], s63 offen lds
    s_add_u32 m0, s60, 38656
    s_nop 0
    buffer_load_dwordx4 v22, s[40:43], s63 offen lds
    s_add_u32 m0, s60, 39680
    s_nop 0
    buffer_load_dwordx4 v23, s[40:43], s63 offen lds
    s_add_u32 m0, s60, 40704
    s_nop 0
    buffer_load_dwordx4 v24, s[40:43], s63 offen lds
    s_add_u32 s60, s60, 9216
    s_add_u32 s63, s63, 73728
    s_cmp_lt_u32 s60, 82944
    s_cbranch_scc1 L_wo1
    s_waitcnt vmcnt(0)
    v_mov_b32 v3, 157256
    v_mov_b32 v6, 1
    s_mov_b64 exec, 1
    ds_add_u32 v3, v6
    s_mov_b64 exec, -1
L_e_n3:
    s_cmp_lt_u32 s2, 192
    s_cselect_b32 s63, 7, 6
    v_mov_b32 v3, 157280
    s_mov_b32 s89, 2097152
L_spin37:
    ds_read_b32 v6, v3
    s_waitcnt lgkmcnt(0)
    v_readfirstlane_b32 s88, v6
    s_nop 0
    s_cmp_ge_u32 s88, s63
    s_cbranch_scc1 L_spun38
    s_sleep 8
    s_sub_u32 s89, s89, 1
    s_cbranch_scc0 L_spin37
L_spun38:
    v_mov_b32 v3, 157288
    s_mov_b32 s89, 2097152
L_spin39:
    ds_read_b32 v6, v3
    s_waitcnt lgkmcnt(0)
    v_readfirstlane_b32 s88, v6
    s_nop 0
    s_cmp_ge_u32 s88, 1
    s_cbranch_scc1 L_spun40
    s_sleep 4
    s_sub_u32 s89, s89, 1
    s_cbranch_scc0 L_spin39
L_spun40:
    s_mov_b64 exec, s[66:67]
    s_mov_b32 s62, 2097152
L_e_poll:
    s_mov_b32 s60, 4194304
    buffer_load_dwordx4 v[80:83], v60, s[36:39], s60 offen sc1
    s_mov_b32 s60, 11534336
    buffer_load_dwordx4 v[96:99], v60, s[52:55], s60 offen sc1
    s_mov_b32 s60, 4198400
    buffer_load_dwordx4 v[84:87], v60, s[36:39], s60 offen sc1
    s_mov_b32 s60, 11538432
    buffer_load_dwordx4 v[100:103], v60, s[52:55], s60 offen sc1
    s_mov_b32 s60, 4202496
    buffer_load_dwordx4 v[88:91], v60, s[36:39], s60 offen sc1
    s_mov_b32 s60, 11542528
    buffer_load_dwordx4 v[104:107], v60, s[52:55], s60 offen sc1
    s_mov_b32 s60, 4206592
    buffer_load_dwordx4 v[92:95], v60, s[36:39], s60 offen sc1
    s_mov_b32 s60, 11546624
    buffer_load_dwordx4 v[108:111], v60, s[52:55], s60 offen sc1
    s_waitcnt vmcnt(0)
    v_max_u32 v3, v80, v81
    v_max3_u32 v3, v3, v82, v83
    v_max3_u32 v3, v3, v84, v85
    v_max3_u32 v3, v3, v86, v87
    v_max3_u32 v3, v3, v88, v89
    v_max3_u32 v3, v3, v90, v91
    v_max3_u32 v3, v3, v92, v93
    v_max3_u32 v3, v3, v94, v95
    v_max3_u32 v3, v3, v96, v97
    v_max3_u32 v3, v3, v98, v99
    v_max3_u32 v3, v3, v100, v101
    v_max3_u32 v3, v3, v102, v103
    v_max3_u32 v3, v3, v104, v105
    v_max3_u32 v3, v3, v106, v107
    v_max3_u32 v3, v3, v108, v109
    v_max3_u32 v3, v3, v110, v111
    v_cmp_eq_u32 vcc, -1, v3
    s_sub_u32 s62, s62, 1
    s_cbranch_scc1 L_e_go
    s_cbranch_vccz L_e_go
    s_sleep 16
    s_branch L_e_poll
L_e_go:
    s_setprio 0
    s_cmp_lt_u32 s4, 16
    s_cbranch_scc1 L_e_one
    v_lshlrev_b32 v38, 16, v80
    v_lshlrev_b32 v39, 16, v84
    v_lshlrev_b32 v36, 16, v96
    v_lshlrev_b32 v37, 16, v100
    v_pk_add_f32 v[38:39], v[38:39], v[36:37]
    v_lshlrev_b32 v36, 16, v112
    v_and_b32 v37, 0xffff0000, v112
    v_pk_mul_f32 v[38:39], v[38:39], v[36:37]
    v_cvt_pk_bf16_f32 v40, v38, v39
    v_lshlrev_b32 v38, 16, v88
    v_lshlrev_b32 v39, 16, v92
    v_lshlrev_b32 v36, 16, v104
    v_lshlrev_b32 v37, 16, v108
    v_pk_add_f32 v[38:39], v[38:39], v[36:37]
    v_lshlrev_b32 v36, 16, v113
    v_and_b32 v37, 0xffff0000, v113
    v_pk_mul_f32 v[38:39], v[38:39], v[36:37]
    v_cvt_pk_bf16_f32 v41, v38, v39
    ds_write_b64 v59, v[40:41] offset:0
    v_and_b32 v38, 0xffff0000, v80
    v_and_b32 v39, 0xffff0000, v84
    v_and_b32 v36, 0xffff0000, v96
    v_and_b32 v37, 0xffff0000, v100
    v_pk_add_f32 v[38:39], v[38:39], v[36:37]
    v_lshlrev_b32 v36, 16, v114
    v_and_b32 v37, 0xffff0000, v114
    v_pk_mul_f32 v[38:39], v[38:39], v[36:37]
    v_cvt_pk_bf16_f32 v42, v38, v39
    v_and_b32 v38, 0xffff0000, v88
    v_and_b32 v39, 0xffff0000, v92
    v_and_b32 v36, 0xffff0000, v104
    v_and_b32 v37, 0xffff0000, v108
    v_pk_add_f32 v[38:39], v[38:39], v[36:37]
    v_lshlrev_b32 v36, 16, v115
    v_and_b32 v37, 0xffff0000, v115
    v_pk_mul_f32 v[38:39], v[38:39], v[36:37]
    v_cvt_pk_bf16_f32 v43, v38, v39
    ds_write_b64 v59, v[42:43] offset:64
    v_lshlrev_b32 v38, 16, v81
    v_lshlrev_b32 v39, 16, v85
    v_lshlrev_b32 v36, 16, v97
    v_lshlrev_b32 v37, 16, v101
    v_pk_add_f32 v[38:39], v[38:39], v[36:37]
    v_lshlrev_b32 v36, 16, v116
    v_and_b32 v37, 0xffff0000, v116
    v_pk_mul_f32 v[38:39], v[38:39], v[36:37]
    v_cvt_pk_bf16_f32 v44, v38, v39
    v_lshlrev_b32 v38, 16, v89
    v_lshlrev_b32 v39, 16, v93
    v_lshlrev_b32 v36, 16, v105
    v_lshlrev_b32 v37, 16, v109
    v_pk_add_f32 v[38:39], v[38:39], v[36:37]
    v_lshlrev_b32 v36, 16, v117
    v_and_b32 v37, 0xffff0000, v117
    v_pk_mul_f32 v[38:39], v[38:39], v[36:37]
    v_cvt_pk_bf16_f32 v45, v38, v39
    ds_write_b64 v59, v[44:45] offset:128
    v_and_b32 v38, 0xffff0000, v81
    v_and_b32 v39, 0xffff0000, v85
    v_and_b32 v36, 0xffff0000, v97
    v_and_b32 v37, 0xffff0000, v101
    v_pk_add_f32 v[38:39], v[38:39], v[36:37]
    v_lshlrev_b32 v36, 16, v118
    v_and_b32 v37, 0xffff0000, v118
    v_pk_mul_f32 v[38:39], v[38:39], v[36:37]
    v_cvt_pk_bf16_f32 v46, v38, v39
    v_and_b32 v38, 0xffff0000, v89
    v_and_b32 v39, 0xffff0000, v93
    v_and_b32 v36, 0xffff0000, v105
    v_and_b32 v37, 0xffff0000, v109
    v_pk_add_f32 v[38:39], v[38:39], v[36:37]
    v_lshlrev_b32 v36, 16, v119
    v_and_b32 v37, 0xffff0000, v119
    v_pk_mul_f32 v[38:39], v[38:39], v[36:37]
    v_cvt_pk_bf16_f32 v47, v38, v39
    ds_write_b64 v59, v[46:47] offset:192
    v_lshlrev_b32 v38, 16, v82
    v_lshlrev_b32 v39, 16, v86
    v_lshlrev_b32 v36, 16, v98
    v_lshlrev_b32 v37, 16, v102
    v_pk_add_f32 v[38:39], v[38:39], v[36:37]
    v_lshlrev_b32 v36, 16, v120
    v_and_b32 v37, 0xffff0000, v120
    v_pk_mul_f32 v[38:39], v[38:39], v[36:37]
    v_cvt_pk_bf16_f32 v48, v38, v39
    v_lshlrev_b32 v38, 16, v90
    v_lshlrev_b32 v39, 16, v94
    v_lshlrev_b32 v36, 16, v106
    v_lshlrev_b32 v37, 16, v110
    v_pk_add_f32 v[38:39], v[38:39], v[36:37]
    v_lshlrev_b32 v36, 16, v121
    v_and_b32 v37, 0xffff0000, v121
    v_pk_mul_f32 v[38:39], v[38:39], v[36:37]
    v_cvt_pk_bf16_f32 v49, v38, v39
    ds_write_b64 v59, v[48:49] offset:256
    v_and_b32 v38, 0xffff0000, v82
    v_and_b32 v39, 0xffff0000, v86
    v_and_b32 v36, 0xffff0000, v98
    v_and_b32 v37, 0xffff0000, v102
    v_pk_add_f32 v[38:39], v[38:39], v[36:37]
    v_lshlrev_b32 v36, 16, v122
    v_and_b32 v37, 0xffff0000, v122
    v_pk_mul_f32 v[38:39], v[38:39], v[36:37]
    v_cvt_pk_bf16_f32 v50, v38, v39
    v_and_b32 v38, 0xffff0000, v90
    v_and_b32 v39, 0xffff0000, v94
    v_and_b32 v36, 0xffff0000, v106
    v_and_b32 v37, 0xffff0000, v110
    v_pk_add_f32 v[38:39], v[38:39], v[36:37]
    v_lshlrev_b32 v36, 16, v123
    v_and_b32 v37, 0xffff0000, v123
    v_pk_mul_f32 v[38:39], v[38:39], v[36:37]
    v_cvt_pk_bf16_f32 v51, v38, v39
    ds_write_b64 v59, v[50:51] offset:320
    v_lshlrev_b32 v38, 16, v83
    v_lshlrev_b32 v39, 16, v87
    v_lshlrev_b32 v36, 16, v99
    v_lshlrev_b32 v37, 16, v103
    v_pk_add_f32 v[38:39], v[38:39], v[36:37]
    v_lshlrev_b32 v36, 16, v124
    v_and_b32 v37, 0xffff0000, v124
    v_pk_mul_f32 v[38:39], v[38:39], v[36:37]
    v_cvt_pk_bf16_f32 v52, v38, v39
    v_lshlrev_b32 v38, 16, v91
    v_lshlrev_b32 v39, 16, v95
    v_lshlrev_b32 v36, 16, v107
    v_lshlrev_b32 v37, 16, v111
    v_pk_add_f32 v[38:39], v[38:39], v[36:37]
    v_lshlrev_b32 v36, 16, v125
    v_and_b32 v37, 0xffff0000, v125
    v_pk_mul_f32 v[38:39], v[38:39], v[36:37]
    v_cvt_pk_bf16_f32 v53, v38, v39
    ds_write_b64 v59, v[52:53] offset:384
    v_and_b32 v38, 0xffff0000, v83
    v_and_b32 v39, 0xffff0000, v87
    v_and_b32 v36, 0xffff0000, v99
    v_and_b32 v37, 0xffff0000, v103
    v_pk_add_f32 v[38:39], v[38:39], v[36:37]
    v_lshlrev_b32 v36, 16, v126
    v_and_b32 v37, 0xffff0000, v126
    v_pk_mul_f32 v[38:39], v[38:39], v[36:37]
    v_cvt_pk_bf16_f32 v54, v38, v39
    v_and_b32 v38, 0xffff0000, v91
    v_and_b32 v39, 0xffff0000, v95
    v_and_b32 v36, 0xffff0000, v107
    v_and_b32 v37, 0xffff0000, v111
    v_pk_add_f32 v[38:39], v[38:39], v[36:37]
    v_lshlrev_b32 v36, 16, v127
    v_and_b32 v37, 0xffff0000, v127
    v_pk_mul_f32 v[38:39], v[38:39], v[36:37]
    v_cvt_pk_bf16_f32 v55, v38, v39
    ds_write_b64 v59, v[54:55] offset:448
    s_branch L_e_st
L_e_one:
    v_lshlrev_b32 v38, 16, v80
    v_lshlrev_b32 v39, 16, v84
    v_lshlrev_b32 v36, 16, v112
    v_and_b32 v37, 0xffff0000, v112
    v_pk_mul_f32 v[38:39], v[38:39], v[36:37]
    v_cvt_pk_bf16_f32 v40, v38, v39
    v_lshlrev_b32 v38, 16, v88
    v_lshlrev_b32 v39, 16, v92
    v_lshlrev_b32 v36, 16, v113
    v_and_b32 v37, 0xffff0000, v113
    v_pk_mul_f32 v[38:39], v[38:39], v[36:37]
    v_cvt_pk_bf16_f32 v41, v38, v39
    ds_write_b64 v59, v[40:41] offset:0
    v_and_b32 v38, 0xffff0000, v80
    v_and_b32 v39, 0xffff0000, v84
    v_lshlrev_b32 v36, 16, v114
    v_and_b32 v37, 0xffff0000, v114
    v_pk_mul_f32 v[38:39], v[38:39], v[36:37]
    v_cvt_pk_bf16_f32 v42, v38, v39
    v_and_b32 v38, 0xffff0000, v88
    v_and_b32 v39, 0xffff0000, v92
    v_lshlrev_b32 v36, 16, v115
    v_and_b32 v37, 0xffff0000, v115
    v_pk_mul_f32 v[38:39], v[38:39], v[36:37]
    v_cvt_pk_bf16_f32 v43, v38, v39
    ds_write_b64 v59, v[42:43] offset:64
    v_lshlrev_b32 v38, 16, v81
    v_lshlrev_b32 v39, 16, v85
    v_lshlrev_b32 v36, 16, v116
    v_and_b32 v37, 0xffff0000, v116
    v_pk_mul_f32 v[38:39], v[38:39], v[36:37]
    v_cvt_pk_bf16_f32 v44, v38, v39
    v_lshlrev_b32 v38, 16, v89
    v_lshlrev_b32 v39, 16, v93
    v_lshlrev_b32 v36, 16, v117
    v_and_b32 v37, 0xffff0000, v117
    v_pk_mul_f32 v[38:39], v[38:39], v[36:37]
    v_cvt_pk_bf16_f32 v45, v38, v39
    ds_write_b64 v59, v[44:45] offset:128
    v_and_b32 v38, 0xffff0000, v81
    v_and_b32 v39, 0xffff0000, v85
    v_lshlrev_b32 v36, 16, v118
    v_and_b32 v37, 0xffff0000, v118
    v_pk_mul_f32 v[38:39], v[38:39], v[36:37]
    v_cvt_pk_bf16_f32 v46, v38, v39
    v_and_b32 v38, 0xffff0000, v89
    v_and_b32 v39, 0xffff0000, v93
    v_lshlrev_b32 v36, 16, v119
    v_and_b32 v37, 0xffff0000, v119
    v_pk_mul_f32 v[38:39], v[38:39], v[36:37]
    v_cvt_pk_bf16_f32 v47, v38, v39
    ds_write_b64 v59, v[46:47] offset:192
    v_lshlrev_b32 v38, 16, v82
    v_lshlrev_b32 v39, 16, v86
    v_lshlrev_b32 v36, 16, v120
    v_and_b32 v37, 0xffff0000, v120
    v_pk_mul_f32 v[38:39], v[38:39], v[36:37]
    v_cvt_pk_bf16_f32 v48, v38, v39
    v_lshlrev_b32 v38, 16, v90
    v_lshlrev_b32 v39, 16, v94
    v_lshlrev_b32 v36, 16, v121
    v_and_b32 v37, 0xffff0000, v121
    v_pk_mul_f32 v[38:39], v[38:39], v[36:37]
    v_cvt_pk_bf16_f32 v49, v38, v39
    ds_write_b64 v59, v[48:49] offset:256
    v_and_b32 v38, 0xffff0000, v82
    v_and_b32 v39, 0xffff0000, v86
    v_lshlrev_b32 v36, 16, v122
    v_and_b32 v37, 0xffff0000, v122
    v_pk_mul_f32 v[38:39], v[38:39], v[36:37]
    v_cvt_pk_bf16_f32 v50, v38, v39
    v_and_b32 v38, 0xffff0000, v90
    v_and_b32 v39, 0xffff0000, v94
    v_lshlrev_b32 v36, 16, v123
    v_and_b32 v37, 0xffff0000, v123
    v_pk_mul_f32 v[38:39], v[38:39], v[36:37]
    v_cvt_pk_bf16_f32 v51, v38, v39
    ds_write_b64 v59, v[50:51] offset:320
    v_lshlrev_b32 v38, 16, v83
    v_lshlrev_b32 v39, 16, v87
    v_lshlrev_b32 v36, 16, v124
    v_and_b32 v37, 0xffff0000, v124
    v_pk_mul_f32 v[38:39], v[38:39], v[36:37]
    v_cvt_pk_bf16_f32 v52, v38, v39
    v_lshlrev_b32 v38, 16, v91
    v_lshlrev_b32 v39, 16, v95
    v_lshlrev_b32 v36, 16, v125
    v_and_b32 v37, 0xffff0000, v125
    v_pk_mul_f32 v[38:39], v[38:39], v[36:37]
    v_cvt_pk_bf16_f32 v53, v38, v39
    ds_write_b64 v59, v[52:53] offset:384
    v_and_b32 v38, 0xffff0000, v83
    v_and_b32 v39, 0xffff0000, v87
    v_lshlrev_b32 v36, 16, v126
    v_and_b32 v37, 0xffff0000, v126
    v_pk_mul_f32 v[38:39], v[38:39], v[36:37]
    v_cvt_pk_bf16_f32 v54, v38, v39
    v_and_b32 v38, 0xffff0000, v91
    v_and_b32 v39, 0xffff0000, v95
    v_lshlrev_b32 v36, 16, v127
    v_and_b32 v37, 0xffff0000, v127
    v_pk_mul_f32 v[38:39], v[38:39], v[36:37]
    v_cvt_pk_bf16_f32 v55, v38, v39
    ds_write_b64 v59, v[54:55] offset:448
L_e_st:
    s_mov_b64 exec, -1
    s_waitcnt lgkmcnt(0)
    ds_read_b128 v[64:67], v61 offset:0
    ds_read_b128 v[68:71], v61 offset:1056
    ds_read_b128 v[72:75], v61 offset:2112
    ds_read_b128 v[76:79], v61 offset:3168
    s_waitcnt lgkmcnt(3)
    buffer_store_dwordx4 v[64:67], v58, s[48:51], s71 offen
    s_add_u32 s71, s71, 36864
    s_cmp_eq_u32 s7, 1
    s_cbranch_scc1 L_h_end
    s_waitcnt lgkmcnt(2)
    buffer_store_dwordx4 v[68:71], v58, s[48:51], s71 offen
    s_add_u32 s71, s71, 36864
    s_waitcnt lgkmcnt(1)
    buffer_store_dwordx4 v[72:75], v58, s[48:51], s71 offen
    s_add_u32 s71, s71, 36864
    s_waitcnt lgkmcnt(0)
    buffer_store_dwordx4 v[76:79], v58, s[48:51], s71 offen
    s_add_u32 s71, s71, 36864
L_h_end:
    s_endpgm
L_att:
    s_lshr_b32 s66, s3, 1
    s_and_b32 s67, s5, 3
    v_lshlrev_b32 v4, 7, v1
    s_waitcnt lgkmcnt(0)
    s_mov_b32 s44, s10
    s_mov_b32 s45, s11
    s_mov_b32 s46, 663552
    s_mov_b32 s47, 0x00020000
    s_barrier
    s_mov_b32 s70, 1
    s_cmp_eq_u32 s66, s67
    s_cbranch_scc1 L_pf3
    s_sub_u32 s92, s3, 2
    s_cmp_gt_u32 s66, s67
    s_cselect_b32 s92, s92, s3
    s_lshl_b32 s93, s4, 3
    s_add_u32 s93, s93, s5
    s_mul_i32 s93, s93, 9216
    s_cmp_ge_u32 s92, 3
    s_cselect_b32 s91, 3, 0
    s_sub_u32 s91, s92, s91
    s_cmp_eq_u32 s91, 0
    s_cselect_b32 s48, s8, s20
    s_cselect_b32 s49, s9, s21
    s_cmp_eq_u32 s91, 2
    s_cselect_b32 s48, s22, s48
    s_cselect_b32 s49, s23, s49
    s_mov_b32 s50, 2359296
    s_mov_b32 s51, 0x00020000
    s_cmp_ge_u32 s92, 3
    s_cbranch_scc1 L_pf2
    s_lshr_b32 s90, s2, 3
    s_mul_i32 s90, s90, 20736
    s_lshl_b32 s91, s92, 13
    s_add_u32 s90, s90, s91
    s_cmp_eq_u32 s92, 2
    s_cselect_b32 exec_hi, 3, -1
    buffer_load_dword v164, v4, s[44:47], s90 offen
    s_mov_b64 exec, 0xff
    s_add_u32 s93, s93, 8192
L_pf2:
    s_cmp_eq_u32 s48, s8
    s_cbranch_scc0 L_pf4
    buffer_load_dword v165, v4, s[48:51], s93 offen
L_pf4:
    s_mov_b64 exec, -1
    s_branch L_nopf
L_pf3:
    s_getpc_b64 s[90:91]
L_pc:
    s_sub_u32 s90, s90, L_pc-concat_heads__grouped_kv_mqa__ssm_conv_h3__prompt_kernel
    s_subb_u32 s91, s91, 0
    s_mov_b32 s70, 0
    s_bitcmp1_b32 s3, 0
    s_cbranch_scc1 L_nopf
    s_lshr_b32 s92, s2, 3
    s_mul_i32 s92, s92, 1536
    v_add_u32 v4, s92, v4
    v_min_u32 v5, L_end-concat_heads__grouped_kv_mqa__ssm_conv_h3__prompt_kernel, v4
    s_mov_b64 exec, 0xfff
    global_load_dword v164, v5, s[90:91]
    s_mov_b64 exec, -1
L_nopf:
    s_lshl_b32 s62, s3, 2
    s_lshl_b32 s64, s3, 3
    v_add_u32 v5, 0, v1
    v_mul_u32_u24 v6, 1639, v5
    v_lshrrev_b32 v6, 16, v6
    v_mul_u32_u24 v7, 40, v6
    v_sub_u32 v5, v5, v7
    v_lshrrev_b32 v7, 1, v6
    v_add_u32 v7, s62, v7
    v_and_b32 v7, 7, v7
    v_xor_b32 v5, v5, v7
    v_mul_u32_u24 v6, 1152, v6
    v_lshl_add_u32 v120, v5, 4, v6
    v_add_u32 v5, 64, v1
    v_mul_u32_u24 v6, 1639, v5
    v_lshrrev_b32 v6, 16, v6
    v_mul_u32_u24 v7, 40, v6
    v_sub_u32 v5, v5, v7
    v_lshrrev_b32 v7, 1, v6
    v_add_u32 v7, s62, v7
    v_and_b32 v7, 7, v7
    v_xor_b32 v5, v5, v7
    v_mul_u32_u24 v6, 1152, v6
    v_lshl_add_u32 v121, v5, 4, v6
    v_add_u32 v5, 128, v1
    v_mul_u32_u24 v6, 1639, v5
    v_lshrrev_b32 v6, 16, v6
    v_mul_u32_u24 v7, 40, v6
    v_sub_u32 v5, v5, v7
    v_lshrrev_b32 v7, 1, v6
    v_add_u32 v7, s62, v7
    v_and_b32 v7, 7, v7
    v_xor_b32 v5, v5, v7
    v_mul_u32_u24 v6, 1152, v6
    v_lshl_add_u32 v122, v5, 4, v6
    v_add_u32 v5, 192, v1
    v_mul_u32_u24 v6, 1639, v5
    v_lshrrev_b32 v6, 16, v6
    v_mul_u32_u24 v7, 40, v6
    v_sub_u32 v5, v5, v7
    v_lshrrev_b32 v7, 1, v6
    v_add_u32 v7, s62, v7
    v_and_b32 v7, 7, v7
    v_xor_b32 v5, v5, v7
    v_mul_u32_u24 v6, 1152, v6
    v_lshl_add_u32 v123, v5, 4, v6
    v_add_u32 v5, 256, v1
    v_mul_u32_u24 v6, 1639, v5
    v_lshrrev_b32 v6, 16, v6
    v_mul_u32_u24 v7, 40, v6
    v_sub_u32 v5, v5, v7
    v_lshrrev_b32 v7, 1, v6
    v_add_u32 v7, s62, v7
    v_and_b32 v7, 7, v7
    v_xor_b32 v5, v5, v7
    v_mul_u32_u24 v6, 1152, v6
    v_lshl_add_u32 v124, v5, 4, v6
    v_add_u32 v5, 0, v0
    v_mul_u32_u24 v6, 7282, v5
    v_lshrrev_b32 v6, 16, v6
    v_mul_u32_u24 v7, 1008, v6
    v_lshl_add_u32 v129, v5, 4, v7
    v_add_u32 v5, 512, v0
    v_mul_u32_u24 v6, 7282, v5
    v_lshrrev_b32 v6, 16, v6
    v_mul_u32_u24 v7, 1008, v6
    v_lshl_add_u32 v130, v5, 4, v7
    v_add_u32 v5, 1024, v0
    v_mul_u32_u24 v6, 7282, v5
    v_lshrrev_b32 v6, 16, v6
    v_mul_u32_u24 v7, 1008, v6
    v_lshl_add_u32 v131, v5, 4, v7
    v_add_u32 v5, 1536, v0
    v_mul_u32_u24 v6, 7282, v5
    v_lshrrev_b32 v6, 16, v6
    v_mul_u32_u24 v7, 1008, v6
    v_lshl_add_u32 v132, v5, 4, v7
    v_add_u32 v5, 2048, v0
    v_mul_u32_u24 v6, 7282, v5
    v_lshrrev_b32 v6, 16, v6
    v_mul_u32_u24 v7, 1008, v6
    v_lshl_add_u32 v133, v5, 4, v7
    v_add_u32 v5, 2560, v0
    v_mul_u32_u24 v6, 7282, v5
    v_lshrrev_b32 v6, 16, v6
    v_mul_u32_u24 v7, 1008, v6
    v_lshl_add_u32 v134, v5, 4, v7
    s_lshl_b32 s60, s4, 6
    s_add_u32 s60, s60, s64
    s_mul_i32 s60, s60, 1152
    s_add_u32 s65, s60, 640
    s_mul_i32 s61, s3, 5120
    s_lshl_b32 s62, s3, 10
    s_mul_i32 s63, s5, 144
    s_mov_b32 s36, s34
    s_mov_b32 s37, s35
    s_mov_b32 s38, 16777216
    s_mov_b32 s39, 0x00020000
    s_mov_b32 s40, s8
    s_mov_b32 s41, s9
    s_mov_b32 s42, 2359296
    s_mov_b32 s43, 0x00020000
    s_cmp_eq_u32 s70, 0
    s_cbranch_scc1 L_a_wq
    s_add_u32 m0, s61, 0
    s_nop 0
    buffer_load_dwordx4 v120, s[40:43], s60 offen lds
    s_add_u32 m0, s61, 1024
    s_nop 0
    buffer_load_dwordx4 v121, s[40:43], s60 offen lds
    s_add_u32 m0, s61, 2048
    s_nop 0
    buffer_load_dwordx4 v122, s[40:43], s60 offen lds
    s_add_u32 m0, s61, 3072
    s_nop 0
    buffer_load_dwordx4 v123, s[40:43], s60 offen lds
    s_add_u32 m0, s61, 4096
    s_nop 0
    buffer_load_dwordx4 v124, s[40:43], s60 offen lds
L_a_wq:
    s_add_u32 m0, s62, 73728
    s_nop 0
    buffer_load_dwordx4 v129, s[44:47], s63 offen lds
    s_add_u32 m0, s62, 81920
    s_nop 0
    buffer_load_dwordx4 v130, s[44:47], s63 offen lds
    s_add_u32 m0, s62, 90112
    s_nop 0
    buffer_load_dwordx4 v131, s[44:47], s63 offen lds
    s_add_u32 m0, s62, 98304
    s_nop 0
    buffer_load_dwordx4 v132, s[44:47], s63 offen lds
    s_add_u32 m0, s62, 106496
    s_nop 0
    buffer_load_dwordx4 v133, s[44:47], s63 offen lds
    s_cmp_ge_u32 s3, 5
    s_cbranch_scc1 L_a_s5
    s_add_u32 m0, s62, 114688
    s_nop 0
    buffer_load_dwordx4 v134, s[44:47], s63 offen lds
L_a_s5:
    v_add_u32 v5, 2880, v0
    v_mul_u32_u24 v6, 7282, v5
    v_lshrrev_b32 v6, 16, v6
    v_mul_u32_u24 v7, 1008, v6
    v_lshl_add_u32 v135, v5, 4, v7
    s_add_u32 m0, s62, 119808
    s_lshl_b32 s92, s3, 3
    buffer_load_dwordx4 v135, s[44:47], s63 offen lds
    s_cmp_eq_u32 s70, 0
    s_cbranch_scc1 L_a_noxb
    s_lshl_b32 s64, s3, 12
    v_lshrrev_b32 v6, 5, v1
    v_add_u32 v6, 0, v6
    v_add_u32 v7, s92, v6
    v_and_b32 v7, 15, v7
    v_and_b32 v5, 31, v1
    v_xor_b32 v5, v5, v7
    v_mul_u32_u24 v6, 1152, v6
    v_lshl_add_u32 v125, v5, 4, v6
    s_add_u32 m0, s64, 40960
    s_nop 0
    buffer_load_dwordx4 v125, s[40:43], s65 offen lds
    v_lshrrev_b32 v6, 5, v1
    v_add_u32 v6, 2, v6
    v_add_u32 v7, s92, v6
    v_and_b32 v7, 15, v7
    v_and_b32 v5, 31, v1
    v_xor_b32 v5, v5, v7
    v_mul_u32_u24 v6, 1152, v6
    v_lshl_add_u32 v126, v5, 4, v6
    s_add_u32 m0, s64, 41984
    s_nop 0
    buffer_load_dwordx4 v126, s[40:43], s65 offen lds
    v_lshrrev_b32 v6, 5, v1
    v_add_u32 v6, 4, v6
    v_add_u32 v7, s92, v6
    v_and_b32 v7, 15, v7
    v_and_b32 v5, 31, v1
    v_xor_b32 v5, v5, v7
    v_mul_u32_u24 v6, 1152, v6
    v_lshl_add_u32 v127, v5, 4, v6
    s_add_u32 m0, s64, 43008
    s_nop 0
    buffer_load_dwordx4 v127, s[40:43], s65 offen lds
    v_lshrrev_b32 v6, 5, v1
    v_add_u32 v6, 6, v6
    v_add_u32 v7, s92, v6
    v_and_b32 v7, 15, v7
    v_and_b32 v5, 31, v1
    v_xor_b32 v5, v5, v7
    v_mul_u32_u24 v6, 1152, v6
    v_lshl_add_u32 v128, v5, 4, v6
    s_add_u32 m0, s64, 44032
    s_nop 0
    buffer_load_dwordx4 v128, s[40:43], s65 offen lds
L_a_noxb:
    v_lshrrev_b32 v4, 5, v1
    v_bfe_u32 v5, v1, 2, 2
    v_lshl_add_u32 v5, v4, 3, v5
    v_mul_u32_u24 v5, 144, v5
    v_and_b32 v6, 1, v1
    v_bfe_u32 v7, v1, 1, 1
    v_bfe_u32 v3, v1, 4, 1
    v_lshl_add_u32 v7, v3, 1, v7
    s_lshr_b32 s60, s3, 1
    s_and_b32 s61, s60, 1
    s_mul_i32 s62, s60, 36
    s_lshl_b32 s64, s61, 2
    s_sub_u32 s62, s62, s64
    s_add_u32 s62, s62, 73728
    s_lshl_b32 s64, s61, 3
    s_add_u32 s64, s64, 16
    v_mul_u32_u24 v6, s64, v6
    v_lshl_add_u32 v6, v7, 3, v6
    v_add3_u32 v64, v5, v6, s62
    v_add_u32 v65, 41472, v64
    s_and_b32 s62, s3, 1
    s_lshl_b32 s62, s62, 5
    v_and_b32 v5, 31, v1
    v_add_u32 v5, s62, v5
    v_bfe_u32 v6, v5, 1, 3
    v_mul_u32_u24 v3, 640, v5
    v_add_u32 v7, 0, v4
    v_xor_b32 v7, v7, v6
    v_lshl_add_u32 v66, v7, 4, v3
    v_add_u32 v7, 2, v4
    v_xor_b32 v7, v7, v6
    v_lshl_add_u32 v67, v7, 4, v3
    v_add_u32 v7, 4, v4
    v_xor_b32 v7, v7, v6
    v_lshl_add_u32 v68, v7, 4, v3
    v_add_u32 v7, 6, v4
    v_xor_b32 v7, v7, v6
    v_lshl_add_u32 v69, v7, 4, v3
    v_and_b32 v6, 15, v5
    v_lshlrev_b32 v3, 9, v5
    v_add_u32 v7, 0, v4
    v_xor_b32 v7, v7, v6
    v_lshl_add_u32 v70, v7, 4, v3
    v_add_u32 v7, 2, v4
    v_xor_b32 v7, v7, v6
    v_lshl_add_u32 v71, v7, 4, v3
    v_add_u32 v7, 4, v4
    v_xor_b32 v7, v7, v6
    v_lshl_add_u32 v72, v7, 4, v3
    v_add_u32 v7, 6, v4
    v_xor_b32 v7, v7, v6
    v_lshl_add_u32 v73, v7, 4, v3
    v_add_u32 v7, 8, v4
    v_xor_b32 v7, v7, v6
    v_lshl_add_u32 v74, v7, 4, v3
    v_add_u32 v7, 10, v4
    v_xor_b32 v7, v7, v6
    v_lshl_add_u32 v75, v7, 4, v3
    v_add_u32 v7, 12, v4
    v_xor_b32 v7, v7, v6
    v_lshl_add_u32 v76, v7, 4, v3
    v_add_u32 v7, 14, v4
    v_xor_b32 v7, v7, v6
    v_lshl_add_u32 v77, v7, 4, v3
    s_mov_b32 s64, 0
    s_mov_b32 s65, -1
    s_cmp_eq_u32 s61, 0
    s_cselect_b32 s66, 0, -1
    s_cselect_b32 s67, -1, 0
    v_lshlrev_b32 v86, 4, v1
    v_and_b32 v5, 31, v1
    v_lshlrev_b32 v87, 2, v5
    v_add_u32 v87, 1024, v87
    v_mul_u32_u24 v6, 288, v4
    v_lshl_add_u32 v6, v5, 4, v6
    v_add_u32 v6, 1152, v6
    v_add_u32 v7, 576, v6
    v_and_b32 v3, 27, v5
    v_cmp_eq_u32 vcc, 18, v3
    v_mov_b32 v3, 262144
    v_mov_b32 v8, 2304
    v_cndmask_b32 v3, v3, v8, vcc
    v_cmp_gt_u32 vcc, 18, v5
    s_nop 1
    v_cndmask_b32 v88, v3, v6, vcc
    v_cndmask_b32 v89, v3, v7, vcc
    v_mov_b32 v92, 1
    v_mov_b32 v48, 0
    v_mov_b32 v49, 0
    v_mov_b32 v50, 0
    v_mov_b32 v51, 0
    v_mov_b32 v52, 0
    v_mov_b32 v53, 0
    v_mov_b32 v54, 0
    v_mov_b32 v55, 0
    v_mov_b32 v56, 0
    v_mov_b32 v57, 0
    v_mov_b32 v58, 0
    v_mov_b32 v59, 0
    v_mov_b32 v60, 0
    v_mov_b32 v61, 0
    v_mov_b32 v62, 0
    v_mov_b32 v63, 0
    v_mov_b32 v96, 0
    v_mov_b32 v97, 0
    v_mov_b32 v98, 0
    v_mov_b32 v99, 0
    v_mov_b32 v100, 0
    v_mov_b32 v101, 0
    v_mov_b32 v102, 0
    v_mov_b32 v103, 0
    v_mov_b32 v104, 0
    v_mov_b32 v105, 0
    v_mov_b32 v106, 0
    v_mov_b32 v107, 0
    v_mov_b32 v108, 0
    v_mov_b32 v109, 0
    v_mov_b32 v110, 0
    v_mov_b32 v111, 0
    s_lshl_b32 s90, s3, 8
    s_add_u32 s90, s90, s2
    s_cmp_ge_u32 s90, 576
    s_cselect_b32 s91, 1, 0
    s_cmp_ge_u32 s90, 1152
    s_cselect_b32 s91, 2, s91
    s_mul_i32 s60, s91, 576
    s_sub_u32 s92, s90, s60
    s_min_u32 s92, s92, 575
    s_cmp_lt_u32 s90, 1728
    s_cselect_b32 s95, s3, 0
    s_cselect_b32 s96, 0, s3
    s_lshl_b32 s60, s92, 12
    s_add_u32 s40, s26, s60
    s_addc_u32 s41, s27, 0
    s_mov_b32 s42, 4096
    s_mov_b32 s43, 0x00020000
    s_add_u32 s61, s60, 1048576
    s_add_u32 s44, s34, s61
    s_addc_u32 s45, s35, 0
    s_mov_b32 s46, 2048
    s_mov_b32 s47, 0x00020000
    s_add_u32 s61, s61, 2048
    s_add_u32 s52, s34, s61
    s_addc_u32 s53, s35, 0
    s_mov_b32 s54, 2048
    s_mov_b32 s55, 0x00020000
    s_cmp_eq_u32 s91, 1
    s_cselect_b32 s61, 7340032, 0
    s_cselect_b32 s62, 2048, 0
    s_sub_u32 s62, s62, 64
    s_add_u32 s93, s60, s61
    s_add_u32 s93, s93, 4194304
    s_cmp_eq_u32 s91, 0
    s_cselect_b32 s61, 0, 2048
    s_add_u32 s93, s93, s61
    s_cmp_eq_u32 s91, 2
    s_cselect_b32 s94, 0, 1024
    s_mul_i32 s60, s3, 1088
    s_add_u32 s60, s60, 148480
    v_lshlrev_b32 v157, 4, v5
    v_add_u32 v157, s62, v157
    v_mov_b32 v3, 0x05040302
    v_mov_b32 v6, 0x07060504
    v_cndmask_b32 v158, v3, v6, s[64:65]
    v_lshlrev_b32 v3, 4, v5
    v_mul_u32_u24 v6, 576, v4
    v_add3_u32 v159, v3, v6, s60
    v_lshrrev_b32 v3, 1, v5
    v_lshlrev_b32 v3, 2, v3
    v_lshl_add_u32 v3, v4, 4, v3
    v_and_b32 v6, 1, v5
    v_mul_u32_u24 v6, 576, v6
    v_add3_u32 v160, v3, v6, s60
    v_sub_u32 v3, 31, v5
    v_lshlrev_b32 v3, 4, v3
    v_lshl_add_u32 v161, v4, 10, v3
    s_lshl_b32 s97, s3, 12
    v_add_u32 v161, s97, v161
    v_lshlrev_b32 v3, 6, v5
    v_lshl_add_u32 v162, v4, 4, v3
    s_lshl_b32 s60, s92, 1
    v_mov_b32 v95, s60
    s_mov_b32 s56, s28
    s_mov_b32 s57, s29
    s_mov_b32 s58, 1152
    s_mov_b32 s59, 0x00020000
    s_lshl_b32 s60, s4, 2
    s_and_b32 s61, s3, 1
    s_lshl_b32 s61, s61, 1
    s_add_u32 s60, s60, s61
    s_mul_i32 s60, s60, 18432
    s_add_u32 s60, s60, 7340032
    s_lshr_b32 s61, s3, 1
    s_lshl_b32 s68, s5, 2
    s_add_u32 s61, s61, s68
    s_lshl_b32 s68, s61, 9
    s_add_u32 s68, s68, s60
    s_lshl_b32 s69, s5, 8
    s_add_u32 s69, s69, s60
    s_lshr_b32 s61, s3, 1
    s_lshl_b32 s61, s61, 2
    s_add_u32 s69, s69, s61
    s_add_u32 s69, s69, 16384
    v_bfe_u32 v5, v1, 4, 1
    v_mul_u32_u24 v7, 18432, v5
    v_and_b32 v5, 15, v1
    v_lshl_add_u32 v167, v5, 4, v7
    v_lshrrev_b32 v6, 5, v1
    v_lshl_add_u32 v166, v6, 8, v167
    s_cmp_eq_u32 s70, 0
    s_cbranch_scc1 L_a_wa1
    s_cmp_eq_u32 s70, 2
    s_cbranch_scc1 L_a_wa3
    s_waitcnt vmcnt(5)
    s_branch L_a_wa2
L_a_wa3:
    s_waitcnt vmcnt(6)
    s_branch L_a_wa2
L_a_wa1:
    s_waitcnt vmcnt(1)
L_a_wa2:
    v_mov_b32 v3, 157200
    v_mov_b32 v6, 1
    s_mov_b64 exec, 1
    ds_add_u32 v3, v6
    s_mov_b64 exec, -1
    v_mov_b32 v3, 157200
    s_mov_b32 s89, 2097152
L_spin41:
    ds_read_b32 v6, v3
    s_waitcnt lgkmcnt(0)
    v_readfirstlane_b32 s88, v6
    s_nop 0
    s_cmp_ge_u32 s88, 12
    s_cbranch_scc1 L_spun42
    s_sleep 1
    s_sub_u32 s89, s89, 1
    s_cbranch_scc0 L_spin41
L_spun42:
    s_setprio 3
    ds_read_b64_tr_b16 v[24:25], v64 offset:0
    ds_read_b64_tr_b16 v[26:27], v64 offset:576
    ds_read_b128 v[36:39], v66 offset:0
    ds_read_b64_tr_b16 v[28:29], v64 offset:2304
    ds_read_b64_tr_b16 v[30:31], v64 offset:2880
    ds_read_b128 v[40:43], v67 offset:0
    ds_read_b64_tr_b16 v[32:33], v64 offset:4608
    ds_read_b64_tr_b16 v[34:35], v64 offset:5184
    ds_read_b128 v[44:47], v68 offset:0
    s_waitcnt lgkmcnt(6)
    v_mfma_f32_32x32x16_bf16 v[8:23], v[24:27], v[36:39], 0
    ds_read_b64_tr_b16 v[24:25], v64 offset:6912
    ds_read_b64_tr_b16 v[26:27], v64 offset:7488
    ds_read_b128 v[36:39], v69 offset:0
    s_waitcnt lgkmcnt(6)
    v_mfma_f32_32x32x16_bf16 v[8:23], v[28:31], v[40:43], v[8:23]
    ds_read_b64_tr_b16 v[28:29], v64 offset:9216
    ds_read_b64_tr_b16 v[30:31], v64 offset:9792
    ds_read_b128 v[40:43], v66 offset:128
    s_waitcnt lgkmcnt(6)
    v_mfma_f32_32x32x16_bf16 v[8:23], v[32:35], v[44:47], v[8:23]
    ds_read_b64_tr_b16 v[32:33], v64 offset:11520
    ds_read_b64_tr_b16 v[34:35], v64 offset:12096
    ds_read_b128 v[44:47], v67 offset:128
    s_waitcnt lgkmcnt(6)
    v_mfma_f32_32x32x16_bf16 v[8:23], v[24:27], v[36:39], v[8:23]
    ds_read_b64_tr_b16 v[24:25], v64 offset:13824
    ds_read_b64_tr_b16 v[26:27], v64 offset:14400
    ds_read_b128 v[36:39], v68 offset:128
    s_waitcnt lgkmcnt(6)
    v_mfma_f32_32x32x16_bf16 v[8:23], v[28:31], v[40:43], v[8:23]
    ds_read_b64_tr_b16 v[28:29], v64 offset:16128
    ds_read_b64_tr_b16 v[30:31], v64 offset:16704
    ds_read_b128 v[40:43], v69 offset:128
    s_waitcnt lgkmcnt(6)
    v_mfma_f32_32x32x16_bf16 v[8:23], v[32:35], v[44:47], v[8:23]
    ds_read_b64_tr_b16 v[32:33], v64 offset:18432
    ds_read_b64_tr_b16 v[34:35], v64 offset:19008
    ds_read_b128 v[44:47], v66 offset:256
    s_waitcnt lgkmcnt(6)
    v_mfma_f32_32x32x16_bf16 v[8:23], v[24:27], v[36:39], v[8:23]
    ds_read_b64_tr_b16 v[24:25], v64 offset:20736
    ds_read_b64_tr_b16 v[26:27], v64 offset:21312
    ds_read_b128 v[36:39], v67 offset:256
    s_waitcnt lgkmcnt(6)
    v_mfma_f32_32x32x16_bf16 v[8:23], v[28:31], v[40:43], v[8:23]
    ds_read_b64_tr_b16 v[28:29], v64 offset:23040
    ds_read_b64_tr_b16 v[30:31], v64 offset:23616
    ds_read_b128 v[40:43], v68 offset:256
    s_waitcnt lgkmcnt(6)
    v_mfma_f32_32x32x16_bf16 v[8:23], v[32:35], v[44:47], v[8:23]
    ds_read_b64_tr_b16 v[32:33], v64 offset:25344
    ds_read_b64_tr_b16 v[34:35], v64 offset:25920
    ds_read_b128 v[44:47], v69 offset:256
    s_waitcnt lgkmcnt(6)
    v_mfma_f32_32x32x16_bf16 v[8:23], v[24:27], v[36:39], v[8:23]
    ds_read_b64_tr_b16 v[24:25], v64 offset:27648
    ds_read_b64_tr_b16 v[26:27], v64 offset:28224
    ds_read_b128 v[36:39], v66 offset:384
    s_waitcnt lgkmcnt(6)
    v_mfma_f32_32x32x16_bf16 v[8:23], v[28:31], v[40:43], v[8:23]
    ds_read_b64_tr_b16 v[28:29], v64 offset:29952
    ds_read_b64_tr_b16 v[30:31], v64 offset:30528
    ds_read_b128 v[40:43], v67 offset:384
    s_waitcnt lgkmcnt(6)
    v_mfma_f32_32x32x16_bf16 v[8:23], v[32:35], v[44:47], v[8:23]
    ds_read_b64_tr_b16 v[32:33], v64 offset:32256
    ds_read_b64_tr_b16 v[34:35], v64 offset:32832
    ds_read_b128 v[44:47], v68 offset:384
    s_waitcnt lgkmcnt(6)
    v_mfma_f32_32x32x16_bf16 v[8:23], v[24:27], v[36:39], v[8:23]
    ds_read_b64_tr_b16 v[24:25], v64 offset:34560
    ds_read_b64_tr_b16 v[26:27], v64 offset:35136
    ds_read_b128 v[36:39], v69 offset:384
    s_waitcnt lgkmcnt(6)
    v_mfma_f32_32x32x16_bf16 v[8:23], v[28:31], v[40:43], v[8:23]
    ds_read_b64_tr_b16 v[28:29], v64 offset:36864
    ds_read_b64_tr_b16 v[30:31], v64 offset:37440
    ds_read_b128 v[40:43], v66 offset:512
    s_waitcnt lgkmcnt(6)
    v_mfma_f32_32x32x16_bf16 v[8:23], v[32:35], v[44:47], v[8:23]
    ds_read_b64_tr_b16 v[32:33], v64 offset:39168
    ds_read_b64_tr_b16 v[34:35], v64 offset:39744
    ds_read_b128 v[44:47], v67 offset:512
    s_waitcnt lgkmcnt(6)
    v_mfma_f32_32x32x16_bf16 v[8:23], v[24:27], v[36:39], v[8:23]
    ds_read_b64_tr_b16 v[24:25], v65 offset:0
    ds_read_b64_tr_b16 v[26:27], v65 offset:576
    ds_read_b128 v[36:39], v68 offset:512
    s_waitcnt lgkmcnt(6)
    v_mfma_f32_32x32x16_bf16 v[8:23], v[28:31], v[40:43], v[8:23]
    ds_read_b64_tr_b16 v[28:29], v65 offset:2304
    ds_read_b64_tr_b16 v[30:31], v65 offset:2880
    ds_read_b128 v[40:43], v69 offset:512
    s_waitcnt lgkmcnt(6)
    v_mfma_f32_32x32x16_bf16 v[8:23], v[32:35], v[44:47], v[8:23]
    s_waitcnt lgkmcnt(3)
    v_mfma_f32_32x32x16_bf16 v[8:23], v[24:27], v[36:39], v[8:23]
    s_waitcnt lgkmcnt(0)
    v_mfma_f32_32x32x16_bf16 v[8:23], v[28:31], v[40:43], v[8:23]
    v_mov_b32 v3, 157272
    v_mov_b32 v6, 1
    s_mov_b64 exec, 1
    ds_add_u32 v3, v6
    s_mov_b64 exec, -1
    s_cmp_eq_u32 s70, 2
    s_cbranch_scc1 L_a_wb1
    s_waitcnt vmcnt(0)
L_a_wb1:
    s_waitcnt vmcnt(1)
    v_mov_b32 v3, 157204
    v_mov_b32 v6, 1
    s_mov_b64 exec, 1
    ds_add_u32 v3, v6
    s_mov_b64 exec, -1
    v_mov_b32 v3, 157204
    s_mov_b32 s89, 2097152
L_spin43:
    ds_read_b32 v6, v3
    s_waitcnt lgkmcnt(0)
    v_readfirstlane_b32 s88, v6
    s_nop 0
    s_cmp_ge_u32 s88, 9
    s_cbranch_scc1 L_spun44
    s_sleep 1
    s_sub_u32 s89, s89, 1
    s_cbranch_scc0 L_spin43
L_spun44:
    v_add_u32 v163, 16, v157
    buffer_load_dwordx4 v[152:155], v157, s[40:43], 0 offen
    buffer_load_dword v156, v163, s[40:43], 0 offen
    v_add_u32 v157, 448, v157
    buffer_load_ushort v94, v95, s[56:59], 0 offen
    ds_read_b64_tr_b16 v[32:33], v65 offset:4608
    ds_read_b64_tr_b16 v[34:35], v65 offset:5184
    ds_read_b128 v[44:47], v70 offset:40960
    ds_read_b64_tr_b16 v[24:25], v65 offset:6912
    ds_read_b64_tr_b16 v[26:27], v65 offset:7488
    ds_read_b128 v[36:39], v71 offset:40960
    ds_read_b64_tr_b16 v[28:29], v65 offset:9216
    ds_read_b64_tr_b16 v[30:31], v65 offset:9792
    ds_read_b128 v[40:43], v72 offset:40960
    s_waitcnt lgkmcnt(6)
    v_mfma_f32_32x32x16_bf16 v[8:23], v[32:35], v[44:47], v[8:23]
    ds_read_b64_tr_b16 v[32:33], v65 offset:11520
    ds_read_b64_tr_b16 v[34:35], v65 offset:12096
    ds_read_b128 v[44:47], v73 offset:40960
    s_waitcnt lgkmcnt(6)
    v_mfma_f32_32x32x16_bf16 v[8:23], v[24:27], v[36:39], v[8:23]
    ds_read_b64_tr_b16 v[24:25], v65 offset:13824
    ds_read_b64_tr_b16 v[26:27], v65 offset:14400
    ds_read_b128 v[36:39], v74 offset:40960
    s_waitcnt lgkmcnt(6)
    v_mfma_f32_32x32x16_bf16 v[8:23], v[28:31], v[40:43], v[8:23]
    ds_read_b64_tr_b16 v[28:29], v65 offset:16128
    ds_read_b64_tr_b16 v[30:31], v65 offset:16704
    ds_read_b128 v[40:43], v75 offset:40960
    s_waitcnt lgkmcnt(6)
    v_mfma_f32_32x32x16_bf16 v[8:23], v[32:35], v[44:47], v[8:23]
    ds_read_b64_tr_b16 v[32:33], v65 offset:18432
    ds_read_b64_tr_b16 v[34:35], v65 offset:19008
    ds_read_b128 v[44:47], v76 offset:40960
    s_waitcnt lgkmcnt(6)
    v_mfma_f32_32x32x16_bf16 v[8:23], v[24:27], v[36:39], v[8:23]
    ds_read_b64_tr_b16 v[24:25], v65 offset:20736
    ds_read_b64_tr_b16 v[26:27], v65 offset:21312
    ds_read_b128 v[36:39], v77 offset:40960
    s_waitcnt lgkmcnt(6)
    v_mfma_f32_32x32x16_bf16 v[8:23], v[28:31], v[40:43], v[8:23]
    ds_read_b64_tr_b16 v[28:29], v65 offset:23040
    ds_read_b64_tr_b16 v[30:31], v65 offset:23616
    ds_read_b128 v[40:43], v70 offset:41216
    s_waitcnt lgkmcnt(6)
    v_mfma_f32_32x32x16_bf16 v[8:23], v[32:35], v[44:47], v[8:23]
    ds_read_b64_tr_b16 v[32:33], v65 offset:25344
    ds_read_b64_tr_b16 v[34:35], v65 offset:25920
    ds_read_b128 v[44:47], v71 offset:41216
    s_waitcnt lgkmcnt(6)
    v_mfma_f32_32x32x16_bf16 v[8:23], v[24:27], v[36:39], v[8:23]
    ds_read_b64_tr_b16 v[24:25], v65 offset:27648
    ds_read_b64_tr_b16 v[26:27], v65 offset:28224
    ds_read_b128 v[36:39], v72 offset:41216
    s_waitcnt lgkmcnt(6)
    v_mfma_f32_32x32x16_bf16 v[8:23], v[28:31], v[40:43], v[8:23]
    ds_read_b64_tr_b16 v[28:29], v65 offset:29952
    ds_read_b64_tr_b16 v[30:31], v65 offset:30528
    ds_read_b128 v[40:43], v73 offset:41216
    s_waitcnt lgkmcnt(6)
    v_mfma_f32_32x32x16_bf16 v[8:23], v[32:35], v[44:47], v[8:23]
    ds_read_b64_tr_b16 v[32:33], v65 offset:32256
    ds_read_b64_tr_b16 v[34:35], v65 offset:32832
    ds_read_b128 v[44:47], v74 offset:41216
    s_waitcnt lgkmcnt(6)
    v_mfma_f32_32x32x16_bf16 v[8:23], v[24:27], v[36:39], v[8:23]
    ds_read_b64_tr_b16 v[24:25], v65 offset:34560
    ds_read_b64_tr_b16 v[26:27], v65 offset:35136
    ds_read_b128 v[36:39], v75 offset:41216
    s_waitcnt lgkmcnt(6)
    v_mfma_f32_32x32x16_bf16 v[8:23], v[28:31], v[40:43], v[8:23]
    ds_read_b64_tr_b16 v[28:29], v65 offset:36864
    ds_read_b64_tr_b16 v[30:31], v65 offset:37440
    ds_read_b128 v[40:43], v76 offset:41216
    s_waitcnt lgkmcnt(6)
    v_mfma_f32_32x32x16_bf16 v[8:23], v[32:35], v[44:47], v[8:23]
    ds_read_b64_tr_b16 v[32:33], v65 offset:39168
    ds_read_b64_tr_b16 v[34:35], v65 offset:39744
    ds_read_b128 v[44:47], v77 offset:41216
    s_waitcnt lgkmcnt(6)
    v_mfma_f32_32x32x16_bf16 v[8:23], v[24:27], v[36:39], v[8:23]
    s_waitcnt lgkmcnt(3)
    v_mfma_f32_32x32x16_bf16 v[8:23], v[28:31], v[40:43], v[8:23]
    s_waitcnt lgkmcnt(0)
    v_mfma_f32_32x32x16_bf16 v[8:23], v[32:35], v[44:47], v[8:23]
    v_mov_b32 v3, 157244
    v_mov_b32 v6, 1
    s_mov_b64 exec, 1
    ds_add_u32 v3, v6
    s_mov_b64 exec, -1
    s_mov_b32 s60, 1051597459
    v_mov_b32 v44, 0
    v_mov_b32 v45, 0
    v_mov_b32 v46, 0
    v_mov_b32 v47, 0
    s_nop 1
    v_mul_f32 v8, s60, v8
    v_mul_f32 v9, s60, v9
    v_mul_f32 v10, s60, v10
    v_mul_f32 v11, s60, v11
    v_mul_f32 v12, s60, v12
    v_mul_f32 v13, s60, v13
    v_mul_f32 v14, s60, v14
    v_mul_f32 v15, s60, v15
    v_mul_f32 v16, s60, v16
    v_mul_f32 v17, s60, v17
    v_mul_f32 v18, s60, v18
    v_mul_f32 v19, s60, v19
    v_cvt_pk_bf16_f32 v24, v8, v9
    v_mul_f32 v32, v8, v8
    v_fmac_f32 v32, v9, v9
    v_cvt_pk_bf16_f32 v25, v10, v11
    v_mul_f32 v33, v10, v10
    v_fmac_f32 v33, v11, v11
    v_cvt_pk_bf16_f32 v26, v12, v13
    v_mul_f32 v34, v12, v12
    v_fmac_f32 v34, v13, v13
    v_cvt_pk_bf16_f32 v27, v14, v15
    v_mul_f32 v35, v14, v14
    v_fmac_f32 v35, v15, v15
    v_cvt_pk_bf16_f32 v28, v16, v17
    v_mul_f32 v36, v16, v16
    v_fmac_f32 v36, v17, v17
    v_cvt_pk_bf16_f32 v29, v18, v19
    v_mul_f32 v37, v18, v18
    v_fmac_f32 v37, v19, v19
    v_cndmask_b32 v80, v24, v25, s[66:67]
    v_cndmask_b32 v81, v25, v26, s[66:67]
    v_cndmask_b32 v82, v26, v27, s[66:67]
    v_cndmask_b32 v83, v27, v28, s[66:67]
    v_cndmask_b32 v84, v28, v29, s[66:67]
    v_cndmask_b32 v84, v84, 0, s[64:65]
    v_cndmask_b32 v40, v32, v36, s[66:67]
    v_cndmask_b32 v41, v36, v37, s[66:67]
    v_cndmask_b32 v41, v41, 0, s[64:65]
    v_add_f32 v40, v40, v41
    v_add_f32 v40, v40, v33
    v_add_f32 v40, v40, v34
    v_add_f32 v40, v40, v35
    v_mov_b32 v41, v40
    s_nop 1
    v_permlane32_swap_b32 v40, v41
    v_add_f32 v40, v40, v41
    v_sqrt_f32 v90, v40
    v_mov_b32 v41, 1114636288
    v_mov_b32 v7, 157224
    v_cvt_pk_bf16_f32 v85, -v90, v41
    v_cndmask_b32 v85, v85, 0, s[64:65]
    v_mov_b32 v4, 1110704128
    v_mov_b32 v3, 157248
    s_mov_b32 s89, 2097152
L_spin45:
    ds_read_b32 v6, v3
    s_waitcnt lgkmcnt(0)
    v_readfirstlane_b32 s88, v6
    s_nop 0
    s_cmp_ge_u32 s88, 2
    s_cbranch_scc1 L_spun46
    s_sleep 0
    s_sub_u32 s89, s89, 1
    s_cbranch_scc0 L_spin45
L_spun46:
    ds_read_b32 v69, v7
    ds_read_b32 v6, v7 offset:4
    ds_read_b128 v[64:67], v86 offset:0
    ds_read_b32 v68, v87 offset:0
    ds_read_b128 v[76:79], v89 offset:0
    s_waitcnt lgkmcnt(3)
    v_readfirstlane_b32 s6, v6
    v_lshlrev_b32 v5, 16, v69
    v_mul_f32 v5, v5, v90
    v_cmp_nle_f32 vcc, v5, v4
    s_cbranch_vccnz L_truemax
L_pass:
    s_waitcnt lgkmcnt(0)
    v_mfma_f32_32x32x16_bf16 v[8:23], v[64:67], v[80:83], 0
    v_mfma_f32_32x32x8_bf16 v[8:23], v[68:69], v[84:85], v[8:23]
    ds_read_b128 v[64:67], v86 offset:2320
    ds_read_b128 v[76:79], v89 offset:0
    ds_read_b32 v68, v87 offset:2320
    ds_read_b128 v[72:75], v88 offset:0
    s_mov_b32 s60, 0
    s_mov_b32 s71, 0
    s_setprio 0
    s_nop 7
.p2align 6
L_loop:
    s_bitcmp1_b32 s3, 2
    s_cbranch_scc0 L_pr0
    s_setprio 1
L_pr0:
    s_waitcnt lgkmcnt(2)
    v_mfma_f32_32x32x16_bf16 v[24:39], v[64:67], v[80:83], 0
    ds_read_b128 v[64:67], v86 offset:4640
    v_exp_f32 v8, v8
    v_exp_f32 v9, v9
    v_exp_f32 v10, v10
    v_exp_f32 v11, v11
    v_cvt_pk_bf16_f32 v40, v8, v9
    v_mfma_f32_32x32x16_bf16 v[48:63], v[76:79], v[44:47], v[48:63]
    ds_read_b128 v[76:79], v89 offset:0
    v_exp_f32 v12, v12
    v_exp_f32 v13, v13
    v_cvt_pk_bf16_f32 v41, v10, v11
    v_exp_f32 v14, v14
    v_exp_f32 v15, v15
    v_cvt_pk_bf16_f32 v42, v12, v13
    s_waitcnt lgkmcnt(2)
    v_mfma_f32_32x32x8_bf16 v[24:39], v[68:69], v[84:85], v[24:39]
    ds_read_b32 v68, v87 offset:4640
    v_exp_f32 v16, v16
    v_cvt_pk_bf16_f32 v43, v14, v15
    v_exp_f32 v17, v17
    v_exp_f32 v18, v18
    v_exp_f32 v19, v19
    v_cvt_pk_bf16_f32 v44, v16, v17
    v_mfma_f32_32x32x16_bf16 v[48:63], v[72:75], v[40:43], v[48:63]
    ds_read_b128 v[72:75], v88 offset:2320
    v_exp_f32 v20, v20
    v_exp_f32 v21, v21
    v_cvt_pk_bf16_f32 v45, v18, v19
    v_exp_f32 v22, v22
    v_exp_f32 v23, v23
    v_cvt_pk_bf16_f32 v46, v20, v21
    v_cvt_pk_bf16_f32 v47, v22, v23
    s_waitcnt lgkmcnt(2)
    v_mfma_f32_32x32x16_bf16 v[8:23], v[64:67], v[80:83], 0
    ds_read_b128 v[64:67], v86 offset:6960
    v_exp_f32 v24, v24
    v_exp_f32 v25, v25
    v_exp_f32 v26, v26
    v_exp_f32 v27, v27
    v_cvt_pk_bf16_f32 v40, v24, v25
    v_mfma_f32_32x32x16_bf16 v[48:63], v[76:79], v[44:47], v[48:63]
    ds_read_b128 v[76:79], v89 offset:2320
    v_exp_f32 v28, v28
    v_exp_f32 v29, v29
    v_cvt_pk_bf16_f32 v41, v26, v27
    v_exp_f32 v30, v30
    v_exp_f32 v31, v31
    v_cvt_pk_bf16_f32 v42, v28, v29
    s_waitcnt lgkmcnt(2)
    v_mfma_f32_32x32x8_bf16 v[8:23], v[68:69], v[84:85], v[8:23]
    ds_read_b32 v68, v87 offset:6960
    v_exp_f32 v32, v32
    v_cvt_pk_bf16_f32 v43, v30, v31
    v_exp_f32 v33, v33
    v_exp_f32 v34, v34
    v_exp_f32 v35, v35
    v_cvt_pk_bf16_f32 v44, v32, v33
    v_mfma_f32_32x32x16_bf16 v[48:63], v[72:75], v[40:43], v[48:63]
    ds_read_b128 v[72:75], v88 offset:4640
    v_exp_f32 v36, v36
    v_exp_f32 v37, v37
    v_cvt_pk_bf16_f32 v45, v34, v35
    v_exp_f32 v38, v38
    v_exp_f32 v39, v39
    v_cvt_pk_bf16_f32 v46, v36, v37
    v_cvt_pk_bf16_f32 v47, v38, v39
    s_waitcnt lgkmcnt(2)
    v_mfma_f32_32x32x16_bf16 v[24:39], v[64:67], v[80:83], 0
    ds_read_b128 v[64:67], v86 offset:9280
    v_exp_f32 v8, v8
    v_exp_f32 v9, v9
    v_exp_f32 v10, v10
    v_exp_f32 v11, v11
    v_cvt_pk_bf16_f32 v40, v8, v9
    v_mfma_f32_32x32x16_bf16 v[48:63], v[76:79], v[44:47], v[48:63]
    ds_read_b128 v[76:79], v89 offset:4640
    v_exp_f32 v12, v12
    v_exp_f32 v13, v13
    v_cvt_pk_bf16_f32 v41, v10, v11
    v_exp_f32 v14, v14
    v_exp_f32 v15, v15
    v_cvt_pk_bf16_f32 v42, v12, v13
    s_waitcnt lgkmcnt(2)
    v_mfma_f32_32x32x8_bf16 v[24:39], v[68:69], v[84:85], v[24:39]
    ds_read_b32 v68, v87 offset:9280
    v_exp_f32 v16, v16
    v_cvt_pk_bf16_f32 v43, v14, v15
    v_exp_f32 v17, v17
    v_exp_f32 v18, v18
    v_exp_f32 v19, v19
    v_cvt_pk_bf16_f32 v44, v16, v17
    v_mfma_f32_32x32x16_bf16 v[48:63], v[72:75], v[40:43], v[48:63]
    ds_read_b128 v[72:75], v88 offset:6960
    v_exp_f32 v20, v20
    v_exp_f32 v21, v21
    v_cvt_pk_bf16_f32 v45, v18, v19
    v_exp_f32 v22, v22
    v_exp_f32 v23, v23
    v_cvt_pk_bf16_f32 v46, v20, v21
    v_cvt_pk_bf16_f32 v47, v22, v23
    s_waitcnt lgkmcnt(2)
    v_mfma_f32_32x32x16_bf16 v[8:23], v[64:67], v[80:83], 0
    ds_read_b128 v[64:67], v86 offset:11600
    v_exp_f32 v24, v24
    v_exp_f32 v25, v25
    v_exp_f32 v26, v26
    v_exp_f32 v27, v27
    v_cvt_pk_bf16_f32 v40, v24, v25
    v_mfma_f32_32x32x16_bf16 v[48:63], v[76:79], v[44:47], v[48:63]
    ds_read_b128 v[76:79], v89 offset:6960
    v_exp_f32 v28, v28
    v_exp_f32 v29, v29
    v_cvt_pk_bf16_f32 v41, v26, v27
    v_exp_f32 v30, v30
    v_exp_f32 v31, v31
    v_cvt_pk_bf16_f32 v42, v28, v29
    s_waitcnt lgkmcnt(2)
    v_mfma_f32_32x32x8_bf16 v[8:23], v[68:69], v[84:85], v[8:23]
    ds_read_b32 v68, v87 offset:11600
    v_exp_f32 v32, v32
    v_cvt_pk_bf16_f32 v43, v30, v31
    v_exp_f32 v33, v33
    v_exp_f32 v34, v34
    v_exp_f32 v35, v35
    v_cvt_pk_bf16_f32 v44, v32, v33
    v_mfma_f32_32x32x16_bf16 v[48:63], v[72:75], v[40:43], v[48:63]
    ds_read_b128 v[72:75], v88 offset:9280
    v_exp_f32 v36, v36
    v_exp_f32 v37, v37
    v_cvt_pk_bf16_f32 v45, v34, v35
    v_exp_f32 v38, v38
    v_exp_f32 v39, v39
    v_cvt_pk_bf16_f32 v46, v36, v37
    v_cvt_pk_bf16_f32 v47, v38, v39
    s_waitcnt lgkmcnt(2)
    v_mfma_f32_32x32x16_bf16 v[24:39], v[64:67], v[80:83], 0
    ds_read_b128 v[64:67], v86 offset:13920
    v_exp_f32 v8, v8
    v_exp_f32 v9, v9
    v_exp_f32 v10, v10
    v_exp_f32 v11, v11
    v_cvt_pk_bf16_f32 v40, v8, v9
    v_mfma_f32_32x32x16_bf16 v[48:63], v[76:79], v[44:47], v[48:63]
    ds_read_b128 v[76:79], v89 offset:9280
    v_exp_f32 v12, v12
    v_exp_f32 v13, v13
    v_cvt_pk_bf16_f32 v41, v10, v11
    v_exp_f32 v14, v14
    v_exp_f32 v15, v15
    v_cvt_pk_bf16_f32 v42, v12, v13
    s_waitcnt lgkmcnt(2)
    v_mfma_f32_32x32x8_bf16 v[24:39], v[68:69], v[84:85], v[24:39]
    ds_read_b32 v68, v87 offset:13920
    v_exp_f32 v16, v16
    v_cvt_pk_bf16_f32 v43, v14, v15
    v_exp_f32 v17, v17
    v_exp_f32 v18, v18
    v_exp_f32 v19, v19
    v_cvt_pk_bf16_f32 v44, v16, v17
    v_mfma_f32_32x32x16_bf16 v[48:63], v[72:75], v[40:43], v[48:63]
    ds_read_b128 v[72:75], v88 offset:11600
    v_exp_f32 v20, v20
    v_exp_f32 v21, v21
    v_cvt_pk_bf16_f32 v45, v18, v19
    v_exp_f32 v22, v22
    v_exp_f32 v23, v23
    v_cvt_pk_bf16_f32 v46, v20, v21
    v_cvt_pk_bf16_f32 v47, v22, v23
    s_bitcmp1_b32 s96, 2
    s_cbranch_scc0 L_pr1
    s_setprio 0
L_pr1:
    s_waitcnt lgkmcnt(2)
    v_mfma_f32_32x32x16_bf16 v[8:23], v[64:67], v[80:83], 0
    ds_read_b128 v[64:67], v86 offset:16240
    v_exp_f32 v24, v24
    v_exp_f32 v25, v25
    v_exp_f32 v26, v26
    v_exp_f32 v27, v27
    v_cvt_pk_bf16_f32 v40, v24, v25
    v_mfma_f32_32x32x16_bf16 v[48:63], v[76:79], v[44:47], v[48:63]
    ds_read_b128 v[76:79], v89 offset:11600
    v_exp_f32 v28, v28
    v_exp_f32 v29, v29
    v_cvt_pk_bf16_f32 v41, v26, v27
    v_exp_f32 v30, v30
    v_exp_f32 v31, v31
    v_cvt_pk_bf16_f32 v42, v28, v29
    s_waitcnt lgkmcnt(2)
    v_mfma_f32_32x32x8_bf16 v[8:23], v[68:69], v[84:85], v[8:23]
    ds_read_b32 v68, v87 offset:16240
    v_exp_f32 v32, v32
    v_cvt_pk_bf16_f32 v43, v30, v31
    v_exp_f32 v33, v33
    v_exp_f32 v34, v34
    v_exp_f32 v35, v35
    v_cvt_pk_bf16_f32 v44, v32, v33
    v_mfma_f32_32x32x16_bf16 v[48:63], v[72:75], v[40:43], v[48:63]
    ds_read_b128 v[72:75], v88 offset:13920
    v_exp_f32 v36, v36
    v_exp_f32 v37, v37
    v_cvt_pk_bf16_f32 v45, v34, v35
    v_exp_f32 v38, v38
    v_exp_f32 v39, v39
    v_cvt_pk_bf16_f32 v46, v36, v37
    v_cvt_pk_bf16_f32 v47, v38, v39
    s_bitcmp1_b32 s95, 2
    s_cbranch_scc0 L_pr47
    s_setprio 0
L_pr47:
    s_waitcnt lgkmcnt(2)
    v_mfma_f32_32x32x16_bf16 v[24:39], v[64:67], v[80:83], 0
    ds_read_b128 v[64:67], v86 offset:18560
    v_exp_f32 v8, v8
    v_exp_f32 v9, v9
    v_exp_f32 v10, v10
    v_exp_f32 v11, v11
    v_cvt_pk_bf16_f32 v40, v8, v9
    v_mfma_f32_32x32x16_bf16 v[48:63], v[76:79], v[44:47], v[48:63]
    ds_read_b128 v[76:79], v89 offset:13920
    v_exp_f32 v12, v12
    v_exp_f32 v13, v13
    v_cvt_pk_bf16_f32 v41, v10, v11
    v_exp_f32 v14, v14
    v_exp_f32 v15, v15
    v_cvt_pk_bf16_f32 v42, v12, v13
    s_waitcnt lgkmcnt(2)
    v_mfma_f32_32x32x8_bf16 v[24:39], v[68:69], v[84:85], v[24:39]
    ds_read_b32 v68, v87 offset:18560
    v_exp_f32 v16, v16
    v_cvt_pk_bf16_f32 v43, v14, v15
    v_exp_f32 v17, v17
    v_exp_f32 v18, v18
    v_exp_f32 v19, v19
    v_cvt_pk_bf16_f32 v44, v16, v17
    v_mfma_f32_32x32x16_bf16 v[48:63], v[72:75], v[40:43], v[48:63]
    ds_read_b128 v[72:75], v88 offset:16240
    v_exp_f32 v20, v20
    v_exp_f32 v21, v21
    v_cvt_pk_bf16_f32 v45, v18, v19
    v_exp_f32 v22, v22
    v_exp_f32 v23, v23
    v_cvt_pk_bf16_f32 v46, v20, v21
    v_cvt_pk_bf16_f32 v47, v22, v23
    s_waitcnt lgkmcnt(2)
    v_mfma_f32_32x32x16_bf16 v[8:23], v[64:67], v[80:83], 0
    ds_read_b128 v[64:67], v86 offset:20880
    v_exp_f32 v24, v24
    v_exp_f32 v25, v25
    v_exp_f32 v26, v26
    v_exp_f32 v27, v27
    v_cvt_pk_bf16_f32 v40, v24, v25
    v_mfma_f32_32x32x16_bf16 v[48:63], v[76:79], v[44:47], v[48:63]
    ds_read_b128 v[76:79], v89 offset:16240
    v_exp_f32 v28, v28
    v_exp_f32 v29, v29
    v_cvt_pk_bf16_f32 v41, v26, v27
    v_exp_f32 v30, v30
    v_exp_f32 v31, v31
    v_cvt_pk_bf16_f32 v42, v28, v29
    s_waitcnt lgkmcnt(2)
    v_mfma_f32_32x32x8_bf16 v[8:23], v[68:69], v[84:85], v[8:23]
    ds_read_b32 v68, v87 offset:20880
    v_exp_f32 v32, v32
    v_cvt_pk_bf16_f32 v43, v30, v31
    v_exp_f32 v33, v33
    v_exp_f32 v34, v34
    v_exp_f32 v35, v35
    v_cvt_pk_bf16_f32 v44, v32, v33
    v_mfma_f32_32x32x16_bf16 v[48:63], v[72:75], v[40:43], v[48:63]
    ds_read_b128 v[72:75], v88 offset:18560
    v_exp_f32 v36, v36
    v_exp_f32 v37, v37
    v_cvt_pk_bf16_f32 v45, v34, v35
    v_exp_f32 v38, v38
    v_exp_f32 v39, v39
    v_cvt_pk_bf16_f32 v46, v36, v37
    v_cvt_pk_bf16_f32 v47, v38, v39
    v_add_u32 v86, 18560, v86
    v_add_u32 v87, 18560, v87
    v_add_u32 v88, 18560, v88
    v_add_u32 v89, 18560, v89
    s_add_u32 s60, s60, 1
    s_cmp_eq_u32 s60, 1
    s_cbranch_scc1 L_loop
    s_cmp_lg_u32 s60, 8
    s_cbranch_scc1 L_edge
L_fini:
    s_waitcnt lgkmcnt(0)
    v_mfma_f32_32x32x16_bf16 v[48:63], v[76:79], v[44:47], v[48:63]
    s_setprio 0
    v_mov_b32 v91, 157288
    s_mov_b32 s89, 2097152
L_spin48:
    ds_read_b32 v93, v91
    s_waitcnt lgkmcnt(0)
    v_readfirstlane_b32 s88, v93
    s_nop 0
    s_cmp_ge_u32 s88, 1
    s_cbranch_scc1 L_spun49
    s_sleep 1
    s_sub_u32 s89, s89, 1
    s_cbranch_scc0 L_spin48
L_spun49:
    s_nop 2
    v_rcp_f32 v4, v58
    s_nop 0
    v_mul_f32 v48, v48, v4
    v_mul_f32 v49, v49, v4
    v_mul_f32 v50, v50, v4
    v_mul_f32 v51, v51, v4
    v_mul_f32 v52, v52, v4
    v_mul_f32 v53, v53, v4
    v_mul_f32 v54, v54, v4
    v_mul_f32 v55, v55, v4
    v_mul_f32 v56, v56, v4
    v_mul_f32 v57, v57, v4
    v_cvt_pk_bf16_f32 v8, v48, v49
    v_cvt_pk_bf16_f32 v9, v50, v51
    v_cvt_pk_bf16_f32 v10, v52, v53
    v_cvt_pk_bf16_f32 v11, v54, v55
    v_cvt_pk_bf16_f32 v12, v56, v57
    v_min_u32 v8, -2, v8
    v_min_u32 v9, -2, v9
    v_min_u32 v10, -2, v10
    v_min_u32 v11, -2, v11
    v_min_u32 v12, -2, v12
    buffer_store_dwordx4 v[8:11], v166, s[36:39], s68 offen sc1
    s_mov_b32 exec_hi, 0
    buffer_store_dword v12, v167, s[36:39], s69 offen sc1
    s_mov_b32 exec_hi, -1
    s_and_b32 s60, s3, 3
    s_lshr_b32 s61, s3, 2
    s_lshl_b32 s62, s4, 2
    s_add_u32 s62, s62, s60
    s_mul_i32 s62, s62, 18432
    s_mul_i32 s64, s61, 9216
    s_add_u32 s62, s62, s64
    s_add_u32 s64, s62, 7340032
    s_add_u32 s65, s64, 4096
    s_add_u32 s70, s64, 8192
    v_lshlrev_b32 v28, 4, v1
    v_and_b32 v4, 15, v1
    v_lshrrev_b32 v5, 4, v1
    s_cmp_eq_u32 s61, 0
    s_cselect_b64 s[66:67], 0, -1
    v_mov_b32 v13, 157260
    v_mov_b32 v14, 1
    s_mov_b64 exec, 1
    ds_add_u32 v13, v14
    s_mov_b64 exec, -1
    s_lshl_b32 s60, s60, 4
    v_add_u32 v36, s60, v4
    v_mul_u32_u24 v36, 336, v36
    v_lshl_add_u32 v36, v5, 4, v36
    s_mul_i32 s60, s61, 115584
    s_add_u32 s60, s60, 0
    v_add_u32 v36, s60, v36
    v_lshrrev_b32 v6, 2, v4
    v_and_b32 v4, 3, v4
    v_lshrrev_b32 v7, 1, v5
    v_mul_u32_u24 v7, 18, v7
    v_and_b32 v3, 1, v5
    v_lshl_add_u32 v7, v3, 2, v7
    v_add_u32 v7, v7, v6
    v_mul_u32_u24 v7, 144, v7
    v_lshl_add_u32 v7, v4, 3, v7
    s_mul_i32 s60, s61, 46656
    s_add_u32 s60, s60, 32512
    v_add_u32 v30, s60, v7
    v_lshrrev_b32 v3, 1, v6
    v_lshl_add_u32 v3, v5, 2, v3
    v_mul_u32_u24 v3, 18, v3
    v_and_b32 v6, 1, v6
    v_add3_u32 v3, v3, v6, 16
    v_mul_u32_u24 v3, 144, v3
    v_lshl_add_u32 v3, v4, 3, v3
    v_add_u32 v3, 32512, v3
    v_add_u32 v6, 36288, v30
    v_add_u32 v7, 0, v3
    v_cndmask_b32 v31, v6, v7, s[66:67]
    v_add_u32 v6, 37440, v30
    v_add_u32 v7, 5184, v3
    v_cndmask_b32 v32, v6, v7, s[66:67]
    v_add_u32 v6, 41472, v30
    v_add_u32 v7, 41472, v3
    v_cndmask_b32 v33, v6, v7, s[66:67]
    v_add_u32 v6, 42624, v30
    v_add_u32 v7, 46656, v3
    v_cndmask_b32 v34, v6, v7, s[66:67]
    v_mov_b32 v3, 157256
    s_mov_b32 s89, 2097152
L_spin50:
    ds_read_b32 v6, v3
    s_waitcnt lgkmcnt(0)
    v_readfirstlane_b32 s88, v6
    s_nop 0
    s_cmp_ge_u32 s88, 1
    s_cbranch_scc1 L_spun51
    s_sleep 1
    s_sub_u32 s89, s89, 1
    s_cbranch_scc0 L_spin50
L_spun51:
    ds_read_b64_tr_b16 v[96:97], v30 offset:0
    ds_read_b64_tr_b16 v[98:99], v30 offset:1152
    ds_read_b64_tr_b16 v[100:101], v30 offset:32
    ds_read_b64_tr_b16 v[102:103], v30 offset:1184
    ds_read_b64_tr_b16 v[104:105], v30 offset:64
    ds_read_b64_tr_b16 v[106:107], v30 offset:1216
    ds_read_b64_tr_b16 v[108:109], v30 offset:96
    ds_read_b64_tr_b16 v[110:111], v30 offset:1248
    ds_read_b64_tr_b16 v[112:113], v30 offset:128
    ds_read_b64_tr_b16 v[114:115], v30 offset:1280
    ds_read_b64_tr_b16 v[116:117], v30 offset:5184
    ds_read_b64_tr_b16 v[118:119], v30 offset:6336
    ds_read_b64_tr_b16 v[120:121], v30 offset:5216
    ds_read_b64_tr_b16 v[122:123], v30 offset:6368
    ds_read_b64_tr_b16 v[124:125], v30 offset:5248
    ds_read_b64_tr_b16 v[126:127], v30 offset:6400
    ds_read_b64_tr_b16 v[128:129], v30 offset:5280
    ds_read_b64_tr_b16 v[130:131], v30 offset:6432
    ds_read_b64_tr_b16 v[132:133], v30 offset:5312
    ds_read_b64_tr_b16 v[134:135], v30 offset:6464
    ds_read_b64_tr_b16 v[136:137], v30 offset:10368
    ds_read_b64_tr_b16 v[138:139], v30 offset:11520
    ds_read_b64_tr_b16 v[140:141], v30 offset:10400
    ds_read_b64_tr_b16 v[142:143], v30 offset:11552
    ds_read_b64_tr_b16 v[144:145], v30 offset:10432
    ds_read_b64_tr_b16 v[146:147], v30 offset:11584
    ds_read_b64_tr_b16 v[148:149], v30 offset:10464
    ds_read_b64_tr_b16 v[150:151], v30 offset:11616
    ds_read_b64_tr_b16 v[152:153], v30 offset:10496
    ds_read_b64_tr_b16 v[154:155], v30 offset:11648
    s_mov_b32 s48, s30
    s_mov_b32 s49, s31
    s_mov_b32 s50, 4718592
    s_mov_b32 s51, 0x00020000
    v_mov_b32 v5, v0
    v_mul_u32_u24 v6, 7282, v5
    v_lshrrev_b32 v6, 16, v6
    v_mul_u32_u24 v7, 9, v6
    v_sub_u32 v5, v5, v7
    v_mul_u32_u24 v7, 336, v6
    v_lshl_add_u32 v37, v5, 5, v7
    v_add_u32 v37, 0, v37
    v_mul_u32_u24 v7, 2304, v6
    v_lshl_add_u32 v38, v5, 4, v7
    v_add_u32 v5, 512, v0
    v_mul_u32_u24 v6, 7282, v5
    v_lshrrev_b32 v6, 16, v6
    v_mul_u32_u24 v7, 9, v6
    v_sub_u32 v5, v5, v7
    v_mul_u32_u24 v7, 336, v6
    v_lshl_add_u32 v35, v5, 5, v7
    v_add_u32 v35, 0, v35
    v_mul_u32_u24 v7, 2304, v6
    v_lshl_add_u32 v39, v5, 4, v7
    s_mul_i32 s63, s5, 144
    s_mul_i32 s60, s4, 147456
    s_add_u32 s63, s63, s60
    v_mov_b32 v3, 157260
    s_mov_b32 s89, 2097152
L_spin52:
    ds_read_b32 v6, v3
    s_waitcnt lgkmcnt(0)
    v_readfirstlane_b32 s88, v6
    s_nop 0
    s_cmp_ge_u32 s88, 8
    s_cbranch_scc1 L_spun53
    s_sleep 1
    s_sub_u32 s89, s89, 1
    s_cbranch_scc0 L_spin52
L_spun53:
    buffer_load_dwordx4 v[40:43], v28, s[36:39], s64 offen offset:0 sc1
    buffer_load_dwordx4 v[44:47], v28, s[36:39], s64 offen offset:1024 sc1
    buffer_load_dwordx4 v[48:51], v28, s[36:39], s64 offen offset:2048 sc1
    buffer_load_dwordx4 v[52:55], v28, s[36:39], s64 offen offset:3072 sc1
    s_mov_b32 s62, 2097152
    s_waitcnt vmcnt(3)
L_ochk54:
    v_max3_u32 v3, v40, v41, v42
    v_max_u32 v3, v3, v43
    v_cmp_eq_u32 vcc, -1, v3
    s_cbranch_vccnz L_ort55
    buffer_load_dwordx4 v[56:59], v28, s[36:39], s65 offen offset:0 sc1
    s_waitcnt lgkmcnt(15)
    v_mfma_f32_16x16x32_bf16 v[76:79], v[96:99], v[40:43], 0
    ds_read_b64_tr_b16 v[156:157], v30 offset:15552
    ds_read_b64_tr_b16 v[158:159], v30 offset:16704
    v_mfma_f32_16x16x32_bf16 v[80:83], v[100:103], v[40:43], 0
    ds_read_b64_tr_b16 v[160:161], v30 offset:15584
    ds_read_b64_tr_b16 v[162:163], v30 offset:16736
    v_mfma_f32_16x16x32_bf16 v[84:87], v[104:107], v[40:43], 0
    ds_read_b64_tr_b16 v[164:165], v30 offset:15616
    ds_read_b64_tr_b16 v[166:167], v30 offset:16768
    v_mfma_f32_16x16x32_bf16 v[88:91], v[108:111], v[40:43], 0
    ds_read_b64_tr_b16 v[96:97], v30 offset:15648
    ds_read_b64_tr_b16 v[98:99], v30 offset:16800
    v_mfma_f32_16x16x32_bf16 v[92:95], v[112:115], v[40:43], 0
    ds_read_b64_tr_b16 v[100:101], v30 offset:15680
    ds_read_b64_tr_b16 v[102:103], v30 offset:16832
    s_waitcnt vmcnt(3)
L_ochk56:
    v_max3_u32 v3, v44, v45, v46
    v_max_u32 v3, v3, v47
    v_cmp_eq_u32 vcc, -1, v3
    s_cbranch_vccnz L_ort57
    buffer_load_dwordx4 v[60:63], v28, s[36:39], s65 offen offset:1024 sc1
    s_waitcnt lgkmcnt(15)
    v_mfma_f32_16x16x32_bf16 v[76:79], v[116:119], v[44:47], v[76:79]
    ds_read_b64_tr_b16 v[104:105], v30 offset:20736
    ds_read_b64_tr_b16 v[106:107], v30 offset:21888
    v_mfma_f32_16x16x32_bf16 v[80:83], v[120:123], v[44:47], v[80:83]
    ds_read_b64_tr_b16 v[108:109], v30 offset:20768
    ds_read_b64_tr_b16 v[110:111], v30 offset:21920
    v_mfma_f32_16x16x32_bf16 v[84:87], v[124:127], v[44:47], v[84:87]
    ds_read_b64_tr_b16 v[112:113], v30 offset:20800
    ds_read_b64_tr_b16 v[114:115], v30 offset:21952
    v_mfma_f32_16x16x32_bf16 v[88:91], v[128:131], v[44:47], v[88:91]
    ds_read_b64_tr_b16 v[116:117], v30 offset:20832
    ds_read_b64_tr_b16 v[118:119], v30 offset:21984
    v_mfma_f32_16x16x32_bf16 v[92:95], v[132:135], v[44:47], v[92:95]
    ds_read_b64_tr_b16 v[120:121], v30 offset:20864
    ds_read_b64_tr_b16 v[122:123], v30 offset:22016
    s_waitcnt vmcnt(3)
L_ochk58:
    v_max3_u32 v3, v48, v49, v50
    v_max_u32 v3, v3, v51
    v_cmp_eq_u32 vcc, -1, v3
    s_cbranch_vccnz L_ort59
    buffer_load_dwordx4 v[64:67], v28, s[36:39], s65 offen offset:2048 sc1
    s_waitcnt lgkmcnt(15)
    v_mfma_f32_16x16x32_bf16 v[76:79], v[136:139], v[48:51], v[76:79]
    ds_read_b64_tr_b16 v[124:125], v30 offset:25920
    ds_read_b64_tr_b16 v[126:127], v30 offset:27072
    v_mfma_f32_16x16x32_bf16 v[80:83], v[140:143], v[48:51], v[80:83]
    ds_read_b64_tr_b16 v[128:129], v30 offset:25952
    ds_read_b64_tr_b16 v[130:131], v30 offset:27104
    v_mfma_f32_16x16x32_bf16 v[84:87], v[144:147], v[48:51], v[84:87]
    ds_read_b64_tr_b16 v[132:133], v30 offset:25984
    ds_read_b64_tr_b16 v[134:135], v30 offset:27136
    v_mfma_f32_16x16x32_bf16 v[88:91], v[148:151], v[48:51], v[88:91]
    ds_read_b64_tr_b16 v[136:137], v30 offset:26016
    ds_read_b64_tr_b16 v[138:139], v30 offset:27168
    v_mfma_f32_16x16x32_bf16 v[92:95], v[152:155], v[48:51], v[92:95]
    ds_read_b64_tr_b16 v[140:141], v30 offset:26048
    ds_read_b64_tr_b16 v[142:143], v30 offset:27200
    s_waitcnt vmcnt(3)
L_ochk60:
    v_max3_u32 v3, v52, v53, v54
    v_max_u32 v3, v3, v55
    v_cmp_eq_u32 vcc, -1, v3
    s_cbranch_vccnz L_ort61
    buffer_load_dwordx4 v[68:71], v28, s[36:39], s65 offen offset:3072 sc1
    s_waitcnt lgkmcnt(15)
    v_mfma_f32_16x16x32_bf16 v[76:79], v[156:159], v[52:55], v[76:79]
    ds_read_b64_tr_b16 v[144:145], v30 offset:31104
    ds_read_b64_tr_b16 v[146:147], v30 offset:32256
    v_mfma_f32_16x16x32_bf16 v[80:83], v[160:163], v[52:55], v[80:83]
    ds_read_b64_tr_b16 v[148:149], v30 offset:31136
    ds_read_b64_tr_b16 v[150:151], v30 offset:32288
    v_mfma_f32_16x16x32_bf16 v[84:87], v[164:167], v[52:55], v[84:87]
    ds_read_b64_tr_b16 v[152:153], v30 offset:31168
    ds_read_b64_tr_b16 v[154:155], v30 offset:32320
    v_mfma_f32_16x16x32_bf16 v[88:91], v[96:99], v[52:55], v[88:91]
    ds_read_b64_tr_b16 v[156:157], v30 offset:31200
    ds_read_b64_tr_b16 v[158:159], v30 offset:32352
    v_mfma_f32_16x16x32_bf16 v[92:95], v[100:103], v[52:55], v[92:95]
    ds_read_b64_tr_b16 v[160:161], v30 offset:31232
    ds_read_b64_tr_b16 v[162:163], v30 offset:32384
    s_waitcnt vmcnt(3)
L_ochk62:
    v_max3_u32 v3, v56, v57, v58
    v_max_u32 v3, v3, v59
    v_cmp_eq_u32 vcc, -1, v3
    s_cbranch_vccnz L_ort63
    buffer_load_dwordx4 v[72:75], v28, s[36:39], s70 offen offset:0 sc1
    s_waitcnt lgkmcnt(15)
    v_mfma_f32_16x16x32_bf16 v[76:79], v[104:107], v[56:59], v[76:79]
    ds_read_b64_tr_b16 v[164:165], v31 offset:0
    ds_read_b64_tr_b16 v[166:167], v32 offset:0
    v_mfma_f32_16x16x32_bf16 v[80:83], v[108:111], v[56:59], v[80:83]
    ds_read_b64_tr_b16 v[96:97], v31 offset:32
    ds_read_b64_tr_b16 v[98:99], v32 offset:32
    v_mfma_f32_16x16x32_bf16 v[84:87], v[112:115], v[56:59], v[84:87]
    ds_read_b64_tr_b16 v[100:101], v31 offset:64
    ds_read_b64_tr_b16 v[102:103], v32 offset:64
    v_mfma_f32_16x16x32_bf16 v[88:91], v[116:119], v[56:59], v[88:91]
    ds_read_b64_tr_b16 v[104:105], v31 offset:96
    ds_read_b64_tr_b16 v[106:107], v32 offset:96
    v_mfma_f32_16x16x32_bf16 v[92:95], v[120:123], v[56:59], v[92:95]
    ds_read_b64_tr_b16 v[108:109], v31 offset:128
    ds_read_b64_tr_b16 v[110:111], v32 offset:128
    s_waitcnt vmcnt(3)
L_ochk64:
    v_max3_u32 v3, v60, v61, v62
    v_max_u32 v3, v3, v63
    v_cmp_eq_u32 vcc, -1, v3
    s_cbranch_vccnz L_ort65
    s_waitcnt lgkmcnt(15)
    v_mfma_f32_16x16x32_bf16 v[76:79], v[124:127], v[60:63], v[76:79]
    ds_read_b64_tr_b16 v[112:113], v33 offset:0
    ds_read_b64_tr_b16 v[114:115], v34 offset:0
    v_mfma_f32_16x16x32_bf16 v[80:83], v[128:131], v[60:63], v[80:83]
    ds_read_b64_tr_b16 v[116:117], v33 offset:32
    ds_read_b64_tr_b16 v[118:119], v34 offset:32
    v_mfma_f32_16x16x32_bf16 v[84:87], v[132:135], v[60:63], v[84:87]
    ds_read_b64_tr_b16 v[120:121], v33 offset:64
    ds_read_b64_tr_b16 v[122:123], v34 offset:64
    v_mfma_f32_16x16x32_bf16 v[88:91], v[136:139], v[60:63], v[88:91]
    ds_read_b64_tr_b16 v[124:125], v33 offset:96
    ds_read_b64_tr_b16 v[126:127], v34 offset:96
    v_mfma_f32_16x16x32_bf16 v[92:95], v[140:143], v[60:63], v[92:95]
    ds_read_b64_tr_b16 v[128:129], v33 offset:128
    ds_read_b64_tr_b16 v[130:131], v34 offset:128
    s_waitcnt vmcnt(2)
L_ochk66:
    v_max3_u32 v3, v64, v65, v66
    v_max_u32 v3, v3, v67
    v_cmp_eq_u32 vcc, -1, v3
    s_cbranch_vccnz L_ort67
    s_waitcnt lgkmcnt(15)
    v_mfma_f32_16x16x32_bf16 v[76:79], v[144:147], v[64:67], v[76:79]
    v_mfma_f32_16x16x32_bf16 v[80:83], v[148:151], v[64:67], v[80:83]
    v_mfma_f32_16x16x32_bf16 v[84:87], v[152:155], v[64:67], v[84:87]
    v_mfma_f32_16x16x32_bf16 v[88:91], v[156:159], v[64:67], v[88:91]
    v_mfma_f32_16x16x32_bf16 v[92:95], v[160:163], v[64:67], v[92:95]
    s_waitcnt vmcnt(1)
L_ochk68:
    v_max3_u32 v3, v68, v69, v70
    v_max_u32 v3, v3, v71
    v_cmp_eq_u32 vcc, -1, v3
    s_cbranch_vccnz L_ort69
    s_waitcnt lgkmcnt(10)
    v_mfma_f32_16x16x32_bf16 v[76:79], v[164:167], v[68:71], v[76:79]
    v_mfma_f32_16x16x32_bf16 v[80:83], v[96:99], v[68:71], v[80:83]
    v_mfma_f32_16x16x32_bf16 v[84:87], v[100:103], v[68:71], v[84:87]
    v_mfma_f32_16x16x32_bf16 v[88:91], v[104:107], v[68:71], v[88:91]
    v_mfma_f32_16x16x32_bf16 v[92:95], v[108:111], v[68:71], v[92:95]
    s_waitcnt vmcnt(0)
L_ochk70:
    v_max3_u32 v3, v72, v73, v74
    v_max_u32 v3, v3, v75
    v_cmp_eq_u32 vcc, -1, v3
    s_cbranch_vccnz L_ort71
    s_waitcnt lgkmcnt(0)
    v_mfma_f32_16x16x32_bf16 v[76:79], v[112:115], v[72:75], v[76:79]
    v_mfma_f32_16x16x32_bf16 v[80:83], v[116:119], v[72:75], v[80:83]
    v_mfma_f32_16x16x32_bf16 v[84:87], v[120:123], v[72:75], v[84:87]
    v_mfma_f32_16x16x32_bf16 v[88:91], v[124:127], v[72:75], v[88:91]
    v_mfma_f32_16x16x32_bf16 v[92:95], v[128:131], v[72:75], v[92:95]
    v_mov_b32 v3, 157260
    s_mov_b32 s89, 2097152
L_spin72:
    ds_read_b32 v6, v3
    s_waitcnt lgkmcnt(0)
    v_readfirstlane_b32 s88, v6
    s_nop 0
    s_cmp_ge_u32 s88, 8
    s_cbranch_scc1 L_spun73
    s_sleep 0
    s_sub_u32 s89, s89, 1
    s_cbranch_scc0 L_spin72
L_spun73:
    ds_write_b128 v36, v[76:79] offset:0
    ds_write_b128 v36, v[80:83] offset:64
    ds_write_b128 v36, v[84:87] offset:128
    ds_write_b128 v36, v[88:91] offset:192
    ds_write_b128 v36, v[92:95] offset:256
    v_mov_b32 v3, 157264
    v_mov_b32 v6, 1
    s_mov_b64 exec, 1
    ds_add_u32 v3, v6
    s_mov_b64 exec, -1
    v_mov_b32 v3, 157264
    s_mov_b32 s89, 2097152
L_spin74:
    ds_read_b32 v6, v3
    s_waitcnt lgkmcnt(0)
    v_readfirstlane_b32 s88, v6
    s_nop 0
    s_cmp_ge_u32 s88, 8
    s_cbranch_scc1 L_spun75
    s_sleep 0
    s_sub_u32 s89, s89, 1
    s_cbranch_scc0 L_spin74
L_spun75:
    ds_read_b128 v[8:11], v37
    v_add_u32 v3, 115584, v37
    ds_read_b128 v[16:19], v3
    ds_read_b128 v[12:15], v37 offset:16
    ds_read_b128 v[20:23], v3 offset:16
    s_waitcnt lgkmcnt(2)
    v_pk_add_f32 v[8:9], v[8:9], v[16:17]
    v_pk_add_f32 v[10:11], v[10:11], v[18:19]
    s_waitcnt lgkmcnt(0)
    v_pk_add_f32 v[12:13], v[12:13], v[20:21]
    v_pk_add_f32 v[14:15], v[14:15], v[22:23]
    v_cvt_pk_bf16_f32 v24, v8, v9
    v_cvt_pk_bf16_f32 v25, v10, v11
    v_cvt_pk_bf16_f32 v26, v12, v13
    v_cvt_pk_bf16_f32 v27, v14, v15
    buffer_store_dwordx4 v[24:27], v38, s[48:51], s63 offen sc1
    s_cmp_lg_u32 s3, 0
    s_cbranch_scc1 L_t_fin
    s_nop 1
    ds_read_b128 v[8:11], v35
    v_add_u32 v3, 115584, v35
    ds_read_b128 v[16:19], v3
    ds_read_b128 v[12:15], v35 offset:16
    ds_read_b128 v[20:23], v3 offset:16
    s_waitcnt lgkmcnt(2)
    v_pk_add_f32 v[8:9], v[8:9], v[16:17]
    v_pk_add_f32 v[10:11], v[10:11], v[18:19]
    s_waitcnt lgkmcnt(0)
    v_pk_add_f32 v[12:13], v[12:13], v[20:21]
    v_pk_add_f32 v[14:15], v[14:15], v[22:23]
    v_cvt_pk_bf16_f32 v24, v8, v9
    v_cvt_pk_bf16_f32 v25, v10, v11
    v_cvt_pk_bf16_f32 v26, v12, v13
    v_cvt_pk_bf16_f32 v27, v14, v15
    buffer_store_dwordx4 v[24:27], v39, s[48:51], s63 offen sc1
L_t_fin:
    s_endpgm
L_ort55:
    s_waitcnt vmcnt(0)
    s_sleep 2
    buffer_load_dwordx4 v[40:43], v28, s[36:39], s64 offen offset:0 sc1
    v_max3_u32 v3, v44, v45, v46
    v_max_u32 v3, v3, v47
    v_cmp_eq_u32 vcc, -1, v3
    s_cbranch_vccz L_osk76
    buffer_load_dwordx4 v[44:47], v28, s[36:39], s64 offen offset:1024 sc1
L_osk76:
    v_max3_u32 v3, v48, v49, v50
    v_max_u32 v3, v3, v51
    v_cmp_eq_u32 vcc, -1, v3
    s_cbranch_vccz L_osk77
    buffer_load_dwordx4 v[48:51], v28, s[36:39], s64 offen offset:2048 sc1
L_osk77:
    v_max3_u32 v3, v52, v53, v54
    v_max_u32 v3, v3, v55
    v_cmp_eq_u32 vcc, -1, v3
    s_cbranch_vccz L_osk78
    buffer_load_dwordx4 v[52:55], v28, s[36:39], s64 offen offset:3072 sc1
L_osk78:
    s_sub_u32 s62, s62, 1
    s_waitcnt vmcnt(0)
    s_cbranch_scc0 L_ochk54
    s_endpgm
L_ort57:
    s_waitcnt vmcnt(0)
    s_sleep 2
    buffer_load_dwordx4 v[44:47], v28, s[36:39], s64 offen offset:1024 sc1
    v_max3_u32 v3, v48, v49, v50
    v_max_u32 v3, v3, v51
    v_cmp_eq_u32 vcc, -1, v3
    s_cbranch_vccz L_osk79
    buffer_load_dwordx4 v[48:51], v28, s[36:39], s64 offen offset:2048 sc1
L_osk79:
    v_max3_u32 v3, v52, v53, v54
    v_max_u32 v3, v3, v55
    v_cmp_eq_u32 vcc, -1, v3
    s_cbranch_vccz L_osk80
    buffer_load_dwordx4 v[52:55], v28, s[36:39], s64 offen offset:3072 sc1
L_osk80:
    v_max3_u32 v3, v56, v57, v58
    v_max_u32 v3, v3, v59
    v_cmp_eq_u32 vcc, -1, v3
    s_cbranch_vccz L_osk81
    buffer_load_dwordx4 v[56:59], v28, s[36:39], s65 offen offset:0 sc1
L_osk81:
    s_sub_u32 s62, s62, 1
    s_waitcnt vmcnt(0)
    s_cbranch_scc0 L_ochk56
    s_endpgm
L_ort59:
    s_waitcnt vmcnt(0)
    s_sleep 2
    buffer_load_dwordx4 v[48:51], v28, s[36:39], s64 offen offset:2048 sc1
    v_max3_u32 v3, v52, v53, v54
    v_max_u32 v3, v3, v55
    v_cmp_eq_u32 vcc, -1, v3
    s_cbranch_vccz L_osk82
    buffer_load_dwordx4 v[52:55], v28, s[36:39], s64 offen offset:3072 sc1
L_osk82:
    v_max3_u32 v3, v56, v57, v58
    v_max_u32 v3, v3, v59
    v_cmp_eq_u32 vcc, -1, v3
    s_cbranch_vccz L_osk83
    buffer_load_dwordx4 v[56:59], v28, s[36:39], s65 offen offset:0 sc1
L_osk83:
    v_max3_u32 v3, v60, v61, v62
    v_max_u32 v3, v3, v63
    v_cmp_eq_u32 vcc, -1, v3
    s_cbranch_vccz L_osk84
    buffer_load_dwordx4 v[60:63], v28, s[36:39], s65 offen offset:1024 sc1
L_osk84:
    s_sub_u32 s62, s62, 1
    s_waitcnt vmcnt(0)
    s_cbranch_scc0 L_ochk58
    s_endpgm
L_ort61:
    s_waitcnt vmcnt(0)
    s_sleep 2
    buffer_load_dwordx4 v[52:55], v28, s[36:39], s64 offen offset:3072 sc1
    v_max3_u32 v3, v56, v57, v58
    v_max_u32 v3, v3, v59
    v_cmp_eq_u32 vcc, -1, v3
    s_cbranch_vccz L_osk85
    buffer_load_dwordx4 v[56:59], v28, s[36:39], s65 offen offset:0 sc1
L_osk85:
    v_max3_u32 v3, v60, v61, v62
    v_max_u32 v3, v3, v63
    v_cmp_eq_u32 vcc, -1, v3
    s_cbranch_vccz L_osk86
    buffer_load_dwordx4 v[60:63], v28, s[36:39], s65 offen offset:1024 sc1
L_osk86:
    v_max3_u32 v3, v64, v65, v66
    v_max_u32 v3, v3, v67
    v_cmp_eq_u32 vcc, -1, v3
    s_cbranch_vccz L_osk87
    buffer_load_dwordx4 v[64:67], v28, s[36:39], s65 offen offset:2048 sc1
L_osk87:
    s_sub_u32 s62, s62, 1
    s_waitcnt vmcnt(0)
    s_cbranch_scc0 L_ochk60
    s_endpgm
L_ort63:
    s_waitcnt vmcnt(0)
    s_sleep 2
    buffer_load_dwordx4 v[56:59], v28, s[36:39], s65 offen offset:0 sc1
    v_max3_u32 v3, v60, v61, v62
    v_max_u32 v3, v3, v63
    v_cmp_eq_u32 vcc, -1, v3
    s_cbranch_vccz L_osk88
    buffer_load_dwordx4 v[60:63], v28, s[36:39], s65 offen offset:1024 sc1
L_osk88:
    v_max3_u32 v3, v64, v65, v66
    v_max_u32 v3, v3, v67
    v_cmp_eq_u32 vcc, -1, v3
    s_cbranch_vccz L_osk89
    buffer_load_dwordx4 v[64:67], v28, s[36:39], s65 offen offset:2048 sc1
L_osk89:
    v_max3_u32 v3, v68, v69, v70
    v_max_u32 v3, v3, v71
    v_cmp_eq_u32 vcc, -1, v3
    s_cbranch_vccz L_osk90
    buffer_load_dwordx4 v[68:71], v28, s[36:39], s65 offen offset:3072 sc1
L_osk90:
    s_sub_u32 s62, s62, 1
    s_waitcnt vmcnt(0)
    s_cbranch_scc0 L_ochk62
    s_endpgm
L_ort65:
    s_waitcnt vmcnt(0)
    s_sleep 2
    buffer_load_dwordx4 v[60:63], v28, s[36:39], s65 offen offset:1024 sc1
    v_max3_u32 v3, v64, v65, v66
    v_max_u32 v3, v3, v67
    v_cmp_eq_u32 vcc, -1, v3
    s_cbranch_vccz L_osk91
    buffer_load_dwordx4 v[64:67], v28, s[36:39], s65 offen offset:2048 sc1
L_osk91:
    v_max3_u32 v3, v68, v69, v70
    v_max_u32 v3, v3, v71
    v_cmp_eq_u32 vcc, -1, v3
    s_cbranch_vccz L_osk92
    buffer_load_dwordx4 v[68:71], v28, s[36:39], s65 offen offset:3072 sc1
L_osk92:
    v_max3_u32 v3, v72, v73, v74
    v_max_u32 v3, v3, v75
    v_cmp_eq_u32 vcc, -1, v3
    s_cbranch_vccz L_osk93
    buffer_load_dwordx4 v[72:75], v28, s[36:39], s70 offen offset:0 sc1
L_osk93:
    s_sub_u32 s62, s62, 1
    s_waitcnt vmcnt(0)
    s_cbranch_scc0 L_ochk64
    s_endpgm
L_ort67:
    s_waitcnt vmcnt(0)
    s_sleep 2
    buffer_load_dwordx4 v[64:67], v28, s[36:39], s65 offen offset:2048 sc1
    v_max3_u32 v3, v68, v69, v70
    v_max_u32 v3, v3, v71
    v_cmp_eq_u32 vcc, -1, v3
    s_cbranch_vccz L_osk94
    buffer_load_dwordx4 v[68:71], v28, s[36:39], s65 offen offset:3072 sc1
L_osk94:
    v_max3_u32 v3, v72, v73, v74
    v_max_u32 v3, v3, v75
    v_cmp_eq_u32 vcc, -1, v3
    s_cbranch_vccz L_osk95
    buffer_load_dwordx4 v[72:75], v28, s[36:39], s70 offen offset:0 sc1
L_osk95:
    s_sub_u32 s62, s62, 1
    s_waitcnt vmcnt(0)
    s_cbranch_scc0 L_ochk66
    s_endpgm
L_ort69:
    s_waitcnt vmcnt(0)
    s_sleep 2
    buffer_load_dwordx4 v[68:71], v28, s[36:39], s65 offen offset:3072 sc1
    v_max3_u32 v3, v72, v73, v74
    v_max_u32 v3, v3, v75
    v_cmp_eq_u32 vcc, -1, v3
    s_cbranch_vccz L_osk96
    buffer_load_dwordx4 v[72:75], v28, s[36:39], s70 offen offset:0 sc1
L_osk96:
    s_sub_u32 s62, s62, 1
    s_waitcnt vmcnt(0)
    s_cbranch_scc0 L_ochk68
    s_endpgm
L_ort71:
    s_waitcnt vmcnt(0)
    s_sleep 2
    buffer_load_dwordx4 v[72:75], v28, s[36:39], s70 offen offset:0 sc1
    s_sub_u32 s62, s62, 1
    s_waitcnt vmcnt(0)
    s_cbranch_scc0 L_ochk70
    s_endpgm
L_edge:
    s_cmp_eq_u32 s60, 2
    s_cbranch_scc1 L_chk
    s_cmp_eq_u32 s60, 7
    s_cbranch_scc1 L_rel2
    s_cmp_eq_u32 s60, 5
    s_cbranch_scc0 L_loop
    v_mov_b32 v91, 157212
    s_mov_b64 exec, 1
    ds_add_u32 v91, v92
    s_mov_b64 exec, -1
    s_waitcnt lgkmcnt(0)
    s_branch L_loop
L_rel2:
    v_mov_b32 v91, 157296
    s_mov_b64 exec, 1
    ds_add_u32 v91, v92
    s_mov_b64 exec, -1
    s_waitcnt lgkmcnt(0)
    s_branch L_loop
L_chk:
    v_mov_b32 v91, 157292
    s_mov_b64 exec, 1
    ds_add_u32 v91, v92
    s_mov_b64 exec, -1
    v_mov_b32 v91, 157208
    s_mov_b32 s89, 2097152
L_spin97:
    ds_read_b32 v93, v91
    s_waitcnt lgkmcnt(0)
    v_readfirstlane_b32 s88, v93
    s_nop 0
    s_cmp_ge_u32 s88, 2
    s_cbranch_scc1 L_spun98
    s_sleep 1
    s_sub_u32 s89, s89, 1
    s_cbranch_scc0 L_spin97
L_spun98:
    s_cmp_lt_u32 s90, 1728
    s_cbranch_scc0 L_loop
L_conv:
    v_mov_b32 v91, 157268
    s_mov_b64 exec, 1
    ds_add_u32 v91, v92
    s_mov_b64 exec, -1
    s_bitcmp1_b32 s95, 2
    s_cbranch_scc0 L_pr99
    s_setprio 1
L_pr99:
    s_waitcnt lgkmcnt(3)
    v_mfma_f32_32x32x16_bf16 v[24:39], v[64:67], v[80:83], 0
    ds_read_b128 v[64:67], v86 offset:4640
    v_exp_f32 v8, v8
    v_exp_f32 v9, v9
    v_exp_f32 v10, v10
    v_exp_f32 v11, v11
    v_cvt_pk_bf16_f32 v40, v8, v9
    v_mfma_f32_32x32x16_bf16 v[48:63], v[76:79], v[44:47], v[48:63]
    ds_read_b128 v[76:79], v89 offset:0
    v_exp_f32 v12, v12
    v_exp_f32 v13, v13
    v_cvt_pk_bf16_f32 v41, v10, v11
    v_exp_f32 v14, v14
    v_exp_f32 v15, v15
    v_cvt_pk_bf16_f32 v42, v12, v13
    s_waitcnt lgkmcnt(3)
    v_mfma_f32_32x32x8_bf16 v[24:39], v[68:69], v[84:85], v[24:39]
    ds_read_b32 v68, v87 offset:4640
    v_exp_f32 v16, v16
    v_cvt_pk_bf16_f32 v43, v14, v15
    v_exp_f32 v17, v17
    v_exp_f32 v18, v18
    v_exp_f32 v19, v19
    v_cvt_pk_bf16_f32 v44, v16, v17
    v_mfma_f32_32x32x16_bf16 v[48:63], v[72:75], v[40:43], v[48:63]
    ds_read_b128 v[72:75], v88 offset:2320
    v_exp_f32 v20, v20
    v_exp_f32 v21, v21
    v_cvt_pk_bf16_f32 v45, v18, v19
    v_exp_f32 v22, v22
    v_exp_f32 v23, v23
    v_cvt_pk_bf16_f32 v46, v20, v21
    v_cvt_pk_bf16_f32 v47, v22, v23
    v_mov_b32 v91, 157252
    s_mov_b32 s89, 2097152
L_spin100:
    ds_read_b32 v93, v91
    s_waitcnt lgkmcnt(0)
    v_readfirstlane_b32 s88, v93
    s_nop 0
    s_cmp_ge_u32 s88, 1
    s_cbranch_scc1 L_spun101
    s_sleep 1
    s_sub_u32 s89, s89, 1
    s_cbranch_scc0 L_spin100
L_spun101:
    v_mov_b32 v91, 157292
    s_mov_b32 s89, 2097152
L_spin102:
    ds_read_b32 v93, v91
    s_waitcnt lgkmcnt(0)
    v_readfirstlane_b32 s88, v93
    s_nop 0
    s_cmp_ge_u32 s88, 8
    s_cbranch_scc1 L_spun103
    s_sleep 1
    s_sub_u32 s89, s89, 1
    s_cbranch_scc0 L_spin102
L_spun103:
    v_lshlrev_b32 v91, 5, v1
    s_add_u32 s61, s94, 16
    s_add_u32 m0, s97, 0
    s_nop 0
    buffer_load_dwordx4 v91, s[44:47], s94 offen sc1 lds
    s_add_u32 m0, s97, 1024
    s_nop 0
    buffer_load_dwordx4 v91, s[44:47], s61 offen sc1 lds
    s_add_u32 m0, s97, 2048
    s_nop 0
    buffer_load_dwordx4 v91, s[52:55], s94 offen sc1 lds
    s_add_u32 m0, s97, 3072
    s_nop 0
    buffer_load_dwordx4 v91, s[52:55], s61 offen sc1 lds
    s_waitcnt vmcnt(4)
    v_lshlrev_b32 v94, 16, v94
    v_lshlrev_b32 v91, 16, v156
    v_add_f32 v91, v91, v94
    s_mov_b32 s61, 0xffff
    v_cvt_pk_bf16_f32 v91, v91, v91
    s_cmp_eq_u32 s91, 1
    s_cselect_b32 exec_lo, 0, 8
    s_cselect_b32 exec_hi, 0, 8
    v_bfi_b32 v156, s61, v91, v156
    s_mov_b64 exec, -1
    v_perm_b32 v152, v153, v152, v158
    v_perm_b32 v153, v154, v153, v158
    v_perm_b32 v154, v155, v154, v158
    v_perm_b32 v155, v156, v155, v158
    ds_write_b128 v159, v[152:155]
    ds_read2_b32 v[112:113], v160 offset0:0 offset1:1
    ds_read2_b32 v[114:115], v160 offset0:2 offset1:3
    ds_read2_b32 v[116:117], v160 offset0:8 offset1:9
    ds_read2_b32 v[118:119], v160 offset0:10 offset1:11
    v_add_u32 v163, 16, v157
    buffer_load_dwordx4 v[152:155], v157, s[40:43], 0 offen
    buffer_load_dword v156, v163, s[40:43], 0 offen
    v_add_u32 v157, 448, v157
    v_mfma_f32_32x32x16_bf16 v[8:23], v[64:67], v[80:83], 0
    ds_read_b128 v[64:67], v86 offset:6960
    v_exp_f32 v24, v24
    v_exp_f32 v25, v25
    v_exp_f32 v26, v26
    v_exp_f32 v27, v27
    v_cvt_pk_bf16_f32 v40, v24, v25
    v_mfma_f32_32x32x16_bf16 v[48:63], v[76:79], v[44:47], v[48:63]
    ds_read_b128 v[76:79], v89 offset:2320
    v_exp_f32 v28, v28
    v_exp_f32 v29, v29
    v_cvt_pk_bf16_f32 v41, v26, v27
    v_exp_f32 v30, v30
    v_exp_f32 v31, v31
    v_cvt_pk_bf16_f32 v42, v28, v29
    v_mfma_f32_32x32x8_bf16 v[8:23], v[68:69], v[84:85], v[8:23]
    ds_read_b32 v68, v87 offset:6960
    v_exp_f32 v32, v32
    v_cvt_pk_bf16_f32 v43, v30, v31
    v_exp_f32 v33, v33
    v_exp_f32 v34, v34
    v_exp_f32 v35, v35
    v_cvt_pk_bf16_f32 v44, v32, v33
    v_mfma_f32_32x32x16_bf16 v[48:63], v[72:75], v[40:43], v[48:63]
    ds_read_b128 v[72:75], v88 offset:4640
    v_exp_f32 v36, v36
    v_exp_f32 v37, v37
    v_cvt_pk_bf16_f32 v45, v34, v35
    v_exp_f32 v38, v38
    v_exp_f32 v39, v39
    v_cvt_pk_bf16_f32 v46, v36, v37
    v_cvt_pk_bf16_f32 v47, v38, v39
    s_waitcnt lgkmcnt(2)
    v_mfma_f32_32x32x16_bf16 v[24:39], v[64:67], v[80:83], 0
    ds_read_b128 v[64:67], v86 offset:9280
    v_exp_f32 v8, v8
    v_exp_f32 v9, v9
    v_exp_f32 v10, v10
    v_exp_f32 v11, v11
    v_cvt_pk_bf16_f32 v40, v8, v9
    v_mfma_f32_32x32x16_bf16 v[48:63], v[76:79], v[44:47], v[48:63]
    ds_read_b128 v[76:79], v89 offset:4640
    v_exp_f32 v12, v12
    v_exp_f32 v13, v13
    v_cvt_pk_bf16_f32 v41, v10, v11
    v_exp_f32 v14, v14
    v_exp_f32 v15, v15
    v_cvt_pk_bf16_f32 v42, v12, v13
    s_waitcnt lgkmcnt(2)
    v_mfma_f32_32x32x8_bf16 v[24:39], v[68:69], v[84:85], v[24:39]
    ds_read_b32 v68, v87 offset:9280
    v_exp_f32 v16, v16
    v_cvt_pk_bf16_f32 v43, v14, v15
    v_exp_f32 v17, v17
    v_exp_f32 v18, v18
    v_exp_f32 v19, v19
    v_cvt_pk_bf16_f32 v44, v16, v17
    v_mfma_f32_32x32x16_bf16 v[48:63], v[72:75], v[40:43], v[48:63]
    ds_read_b128 v[72:75], v88 offset:6960
    v_exp_f32 v20, v20
    v_exp_f32 v21, v21
    v_cvt_pk_bf16_f32 v45, v18, v19
    v_exp_f32 v22, v22
    v_exp_f32 v23, v23
    v_cvt_pk_bf16_f32 v46, v20, v21
    v_cvt_pk_bf16_f32 v47, v22, v23
    s_waitcnt vmcnt(2)
    ds_read_b128 v[120:123], v161 offset:0
    ds_read_b128 v[124:127], v161 offset:2048
    s_waitcnt lgkmcnt(4)
    v_mfma_f32_32x32x16_bf16 v[8:23], v[64:67], v[80:83], 0
    ds_read_b128 v[64:67], v86 offset:11600
    v_exp_f32 v24, v24
    v_exp_f32 v25, v25
    v_exp_f32 v26, v26
    v_exp_f32 v27, v27
    v_cvt_pk_bf16_f32 v40, v24, v25
    v_mfma_f32_32x32x16_bf16 v[48:63], v[76:79], v[44:47], v[48:63]
    ds_read_b128 v[76:79], v89 offset:6960
    v_exp_f32 v28, v28
    v_exp_f32 v29, v29
    v_cvt_pk_bf16_f32 v41, v26, v27
    v_exp_f32 v30, v30
    v_exp_f32 v31, v31
    v_cvt_pk_bf16_f32 v42, v28, v29
    s_waitcnt lgkmcnt(4)
    v_mfma_f32_32x32x8_bf16 v[8:23], v[68:69], v[84:85], v[8:23]
    ds_read_b32 v68, v87 offset:11600
    v_exp_f32 v32, v32
    v_cvt_pk_bf16_f32 v43, v30, v31
    v_exp_f32 v33, v33
    v_exp_f32 v34, v34
    v_exp_f32 v35, v35
    v_cvt_pk_bf16_f32 v44, v32, v33
    v_mfma_f32_32x32x16_bf16 v[48:63], v[72:75], v[40:43], v[48:63]
    ds_read_b128 v[72:75], v88 offset:9280
    v_exp_f32 v36, v36
    v_exp_f32 v37, v37
    v_cvt_pk_bf16_f32 v45, v34, v35
    v_exp_f32 v38, v38
    v_exp_f32 v39, v39
    v_cvt_pk_bf16_f32 v46, v36, v37
    v_cvt_pk_bf16_f32 v47, v38, v39
    s_waitcnt lgkmcnt(2)
    v_mfma_f32_32x32x16_bf16 v[24:39], v[64:67], v[80:83], 0
    ds_read_b128 v[64:67], v86 offset:13920
    v_exp_f32 v8, v8
    v_exp_f32 v9, v9
    v_exp_f32 v10, v10
    v_mfma_f32_32x32x16_bf16 v[48:63], v[76:79], v[44:47], v[48:63]
    ds_read_b128 v[76:79], v89 offset:9280
    v_exp_f32 v11, v11
    v_cvt_pk_bf16_f32 v40, v8, v9
    v_exp_f32 v12, v12
    v_cvt_pk_bf16_f32 v41, v10, v11
    v_exp_f32 v13, v13
    v_mfma_f32_32x32x16_bf16 v[96:111], v[112:115], v[120:123], v[96:111]
    ds_read2_b32 v[112:113], v160 offset0:16 offset1:17
    ds_read2_b32 v[114:115], v160 offset0:18 offset1:19
    ds_read_b128 v[120:123], v161 offset:16
    v_exp_f32 v14, v14
    v_exp_f32 v15, v15
    v_cvt_pk_bf16_f32 v42, v12, v13
    v_exp_f32 v16, v16
    s_waitcnt lgkmcnt(5)
    v_mfma_f32_32x32x8_bf16 v[24:39], v[68:69], v[84:85], v[24:39]
    ds_read_b32 v68, v87 offset:13920
    v_cvt_pk_bf16_f32 v43, v14, v15
    v_exp_f32 v17, v17
    v_exp_f32 v18, v18
    v_exp_f32 v19, v19
    v_mfma_f32_32x32x16_bf16 v[48:63], v[72:75], v[40:43], v[48:63]
    ds_read_b128 v[72:75], v88 offset:11600
    v_cvt_pk_bf16_f32 v44, v16, v17
    v_exp_f32 v20, v20
    v_exp_f32 v21, v21
    v_cvt_pk_bf16_f32 v45, v18, v19
    v_mfma_f32_32x32x16_bf16 v[96:111], v[116:119], v[124:127], v[96:111]
    ds_read2_b32 v[116:117], v160 offset0:24 offset1:25
    ds_read2_b32 v[118:119], v160 offset0:26 offset1:27
    ds_read_b128 v[124:127], v161 offset:2064
    v_exp_f32 v22, v22
    v_exp_f32 v23, v23
    v_cvt_pk_bf16_f32 v46, v20, v21
    v_cvt_pk_bf16_f32 v47, v22, v23
    s_bitcmp1_b32 s95, 2
    s_cbranch_scc0 L_pr104
    s_setprio 0
L_pr104:
    s_waitcnt lgkmcnt(8)
    v_mfma_f32_32x32x16_bf16 v[8:23], v[64:67], v[80:83], 0
    ds_read_b128 v[64:67], v86 offset:16240
    v_exp_f32 v24, v24
    v_exp_f32 v25, v25
    v_exp_f32 v26, v26
    v_mfma_f32_32x32x16_bf16 v[48:63], v[76:79], v[44:47], v[48:63]
    ds_read_b128 v[76:79], v89 offset:11600
    v_exp_f32 v27, v27
    v_cvt_pk_bf16_f32 v40, v24, v25
    v_exp_f32 v28, v28
    v_cvt_pk_bf16_f32 v41, v26, v27
    v_exp_f32 v29, v29
    s_waitcnt lgkmcnt(7)
    v_mfma_f32_32x32x16_bf16 v[96:111], v[112:115], v[120:123], v[96:111]
    ds_read2_b32 v[112:113], v160 offset0:32 offset1:33
    ds_read2_b32 v[114:115], v160 offset0:34 offset1:35
    ds_read_b128 v[120:123], v161 offset:32
    v_exp_f32 v30, v30
    v_exp_f32 v31, v31
    v_cvt_pk_bf16_f32 v42, v28, v29
    v_exp_f32 v32, v32
    s_waitcnt lgkmcnt(8)
    v_mfma_f32_32x32x8_bf16 v[8:23], v[68:69], v[84:85], v[8:23]
    ds_read_b32 v68, v87 offset:16240
    v_cvt_pk_bf16_f32 v43, v30, v31
    v_exp_f32 v33, v33
    v_exp_f32 v34, v34
    v_exp_f32 v35, v35
    v_mfma_f32_32x32x16_bf16 v[48:63], v[72:75], v[40:43], v[48:63]
    ds_read_b128 v[72:75], v88 offset:13920
    v_cvt_pk_bf16_f32 v44, v32, v33
    v_exp_f32 v36, v36
    v_exp_f32 v37, v37
    v_cvt_pk_bf16_f32 v45, v34, v35
    s_waitcnt lgkmcnt(7)
    v_mfma_f32_32x32x16_bf16 v[96:111], v[116:119], v[124:127], v[96:111]
    ds_read2_b32 v[116:117], v160 offset0:40 offset1:41
    ds_read2_b32 v[118:119], v160 offset0:42 offset1:43
    ds_read_b128 v[124:127], v161 offset:2080
    v_exp_f32 v38, v38
    v_exp_f32 v39, v39
    v_cvt_pk_bf16_f32 v46, v36, v37
    v_cvt_pk_bf16_f32 v47, v38, v39
    s_waitcnt lgkmcnt(8)
    v_mfma_f32_32x32x16_bf16 v[24:39], v[64:67], v[80:83], 0
    ds_read_b128 v[64:67], v86 offset:18560
    v_exp_f32 v8, v8
    v_exp_f32 v9, v9
    v_exp_f32 v10, v10
    v_mfma_f32_32x32x16_bf16 v[48:63], v[76:79], v[44:47], v[48:63]
    ds_read_b128 v[76:79], v89 offset:13920
    v_exp_f32 v11, v11
    v_cvt_pk_bf16_f32 v40, v8, v9
    v_exp_f32 v12, v12
    v_cvt_pk_bf16_f32 v41, v10, v11
    v_exp_f32 v13, v13
    s_waitcnt lgkmcnt(7)
    v_mfma_f32_32x32x16_bf16 v[96:111], v[112:115], v[120:123], v[96:111]
    ds_read2_b32 v[112:113], v160 offset0:48 offset1:49
    ds_read2_b32 v[114:115], v160 offset0:50 offset1:51
    ds_read_b128 v[120:123], v161 offset:48
    v_exp_f32 v14, v14
    v_exp_f32 v15, v15
    v_cvt_pk_bf16_f32 v42, v12, v13
    v_exp_f32 v16, v16
    s_waitcnt lgkmcnt(8)
    v_mfma_f32_32x32x8_bf16 v[24:39], v[68:69], v[84:85], v[24:39]
    ds_read_b32 v68, v87 offset:18560
    v_cvt_pk_bf16_f32 v43, v14, v15
    v_exp_f32 v17, v17
    v_exp_f32 v18, v18
    v_exp_f32 v19, v19
    v_mfma_f32_32x32x16_bf16 v[48:63], v[72:75], v[40:43], v[48:63]
    ds_read_b128 v[72:75], v88 offset:16240
    v_cvt_pk_bf16_f32 v44, v16, v17
    v_exp_f32 v20, v20
    v_exp_f32 v21, v21
    v_cvt_pk_bf16_f32 v45, v18, v19
    s_waitcnt lgkmcnt(7)
    v_mfma_f32_32x32x16_bf16 v[96:111], v[116:119], v[124:127], v[96:111]
    ds_read2_b32 v[116:117], v160 offset0:56 offset1:57
    ds_read2_b32 v[118:119], v160 offset0:58 offset1:59
    ds_read_b128 v[124:127], v161 offset:2096
    v_exp_f32 v22, v22
    v_exp_f32 v23, v23
    v_cvt_pk_bf16_f32 v46, v20, v21
    v_cvt_pk_bf16_f32 v47, v22, v23
    s_waitcnt lgkmcnt(8)
    v_mfma_f32_32x32x16_bf16 v[8:23], v[64:67], v[80:83], 0
    ds_read_b128 v[64:67], v86 offset:20880
    v_exp_f32 v24, v24
    v_exp_f32 v25, v25
    v_exp_f32 v26, v26
    v_mfma_f32_32x32x16_bf16 v[48:63], v[76:79], v[44:47], v[48:63]
    ds_read_b128 v[76:79], v89 offset:16240
    v_exp_f32 v27, v27
    v_cvt_pk_bf16_f32 v40, v24, v25
    v_exp_f32 v28, v28
    v_cvt_pk_bf16_f32 v41, v26, v27
    v_exp_f32 v29, v29
    s_waitcnt lgkmcnt(7)
    v_mfma_f32_32x32x16_bf16 v[96:111], v[112:115], v[120:123], v[96:111]
    ds_read2_b32 v[112:113], v160 offset0:64 offset1:65
    ds_read2_b32 v[114:115], v160 offset0:66 offset1:67
    ds_read_b128 v[120:123], v161 offset:64
    v_exp_f32 v30, v30
    v_exp_f32 v31, v31
    v_cvt_pk_bf16_f32 v42, v28, v29
    v_exp_f32 v32, v32
    s_waitcnt lgkmcnt(8)
    v_mfma_f32_32x32x8_bf16 v[8:23], v[68:69], v[84:85], v[8:23]
    ds_read_b32 v68, v87 offset:20880
    v_cvt_pk_bf16_f32 v43, v30, v31
    v_exp_f32 v33, v33
    v_exp_f32 v34, v34
    v_exp_f32 v35, v35
    v_mfma_f32_32x32x16_bf16 v[48:63], v[72:75], v[40:43], v[48:63]
    ds_read_b128 v[72:75], v88 offset:18560
    v_cvt_pk_bf16_f32 v44, v32, v33
    v_exp_f32 v36, v36
    v_exp_f32 v37, v37
    v_cvt_pk_bf16_f32 v45, v34, v35
    s_waitcnt lgkmcnt(7)
    v_mfma_f32_32x32x16_bf16 v[96:111], v[116:119], v[124:127], v[96:111]
    ds_read2_b32 v[116:117], v160 offset0:72 offset1:73
    ds_read2_b32 v[118:119], v160 offset0:74 offset1:75
    ds_read_b128 v[124:127], v161 offset:2112
    v_exp_f32 v38, v38
    v_exp_f32 v39, v39
    v_cvt_pk_bf16_f32 v46, v36, v37
    v_cvt_pk_bf16_f32 v47, v38, v39
    s_bitcmp1_b32 s95, 2
    s_cbranch_scc0 L_pr105
    s_setprio 1
L_pr105:
    s_waitcnt lgkmcnt(8)
    v_mfma_f32_32x32x16_bf16 v[24:39], v[64:67], v[80:83], 0
    ds_read_b128 v[64:67], v86 offset:23200
    v_exp_f32 v8, v8
    v_exp_f32 v9, v9
    v_exp_f32 v10, v10
    v_mfma_f32_32x32x16_bf16 v[48:63], v[76:79], v[44:47], v[48:63]
    ds_read_b128 v[76:79], v89 offset:18560
    v_exp_f32 v11, v11
    v_cvt_pk_bf16_f32 v40, v8, v9
    v_exp_f32 v12, v12
    v_cvt_pk_bf16_f32 v41, v10, v11
    v_exp_f32 v13, v13
    s_waitcnt lgkmcnt(7)
    v_mfma_f32_32x32x16_bf16 v[96:111], v[112:115], v[120:123], v[96:111]
    ds_read2_b32 v[112:113], v160 offset0:80 offset1:81
    ds_read2_b32 v[114:115], v160 offset0:82 offset1:83
    ds_read_b128 v[120:123], v161 offset:80
    v_exp_f32 v14, v14
    v_exp_f32 v15, v15
    v_cvt_pk_bf16_f32 v42, v12, v13
    v_exp_f32 v16, v16
    s_waitcnt lgkmcnt(8)
    v_mfma_f32_32x32x8_bf16 v[24:39], v[68:69], v[84:85], v[24:39]
    ds_read_b32 v68, v87 offset:23200
    v_cvt_pk_bf16_f32 v43, v14, v15
    v_exp_f32 v17, v17
    v_exp_f32 v18, v18
    v_exp_f32 v19, v19
    v_mfma_f32_32x32x16_bf16 v[48:63], v[72:75], v[40:43], v[48:63]
    ds_read_b128 v[72:75], v88 offset:20880
    v_cvt_pk_bf16_f32 v44, v16, v17
    v_exp_f32 v20, v20
    v_exp_f32 v21, v21
    v_cvt_pk_bf16_f32 v45, v18, v19
    s_waitcnt lgkmcnt(7)
    v_mfma_f32_32x32x16_bf16 v[96:111], v[116:119], v[124:127], v[96:111]
    ds_read2_b32 v[116:117], v160 offset0:88 offset1:89
    ds_read2_b32 v[118:119], v160 offset0:90 offset1:91
    ds_read_b128 v[124:127], v161 offset:2128
    v_exp_f32 v22, v22
    v_exp_f32 v23, v23
    v_cvt_pk_bf16_f32 v46, v20, v21
    v_cvt_pk_bf16_f32 v47, v22, v23
    s_waitcnt lgkmcnt(8)
    v_mfma_f32_32x32x16_bf16 v[8:23], v[64:67], v[80:83], 0
    ds_read_b128 v[64:67], v86 offset:25520
    v_exp_f32 v24, v24
    v_exp_f32 v25, v25
    v_exp_f32 v26, v26
    v_mfma_f32_32x32x16_bf16 v[48:63], v[76:79], v[44:47], v[48:63]
    ds_read_b128 v[76:79], v89 offset:20880
    v_exp_f32 v27, v27
    v_cvt_pk_bf16_f32 v40, v24, v25
    v_exp_f32 v28, v28
    v_cvt_pk_bf16_f32 v41, v26, v27
    v_exp_f32 v29, v29
    s_waitcnt lgkmcnt(7)
    v_mfma_f32_32x32x16_bf16 v[96:111], v[112:115], v[120:123], v[96:111]
    ds_read2_b32 v[112:113], v160 offset0:96 offset1:97
    ds_read2_b32 v[114:115], v160 offset0:98 offset1:99
    ds_read_b128 v[120:123], v161 offset:96
    v_exp_f32 v30, v30
    v_exp_f32 v31, v31
    v_cvt_pk_bf16_f32 v42, v28, v29
    v_exp_f32 v32, v32
    s_waitcnt lgkmcnt(8)
    v_mfma_f32_32x32x8_bf16 v[8:23], v[68:69], v[84:85], v[8:23]
    ds_read_b32 v68, v87 offset:25520
    v_cvt_pk_bf16_f32 v43, v30, v31
    v_exp_f32 v33, v33
    v_exp_f32 v34, v34
    v_exp_f32 v35, v35
    v_mfma_f32_32x32x16_bf16 v[48:63], v[72:75], v[40:43], v[48:63]
    ds_read_b128 v[72:75], v88 offset:23200
    v_cvt_pk_bf16_f32 v44, v32, v33
    v_exp_f32 v36, v36
    v_exp_f32 v37, v37
    v_cvt_pk_bf16_f32 v45, v34, v35
    s_waitcnt lgkmcnt(7)
    v_mfma_f32_32x32x16_bf16 v[96:111], v[116:119], v[124:127], v[96:111]
    ds_read2_b32 v[116:117], v160 offset0:104 offset1:105
    ds_read2_b32 v[118:119], v160 offset0:106 offset1:107
    ds_read_b128 v[124:127], v161 offset:2144
    v_exp_f32 v38, v38
    v_exp_f32 v39, v39
    v_cvt_pk_bf16_f32 v46, v36, v37
    v_cvt_pk_bf16_f32 v47, v38, v39
    s_waitcnt lgkmcnt(8)
    v_mfma_f32_32x32x16_bf16 v[24:39], v[64:67], v[80:83], 0
    ds_read_b128 v[64:67], v86 offset:27840
    v_exp_f32 v8, v8
    v_exp_f32 v9, v9
    v_exp_f32 v10, v10
    v_mfma_f32_32x32x16_bf16 v[48:63], v[76:79], v[44:47], v[48:63]
    ds_read_b128 v[76:79], v89 offset:23200
    v_exp_f32 v11, v11
    v_cvt_pk_bf16_f32 v40, v8, v9
    v_exp_f32 v12, v12
    v_cvt_pk_bf16_f32 v41, v10, v11
    v_exp_f32 v13, v13
    s_waitcnt vmcnt(0) lgkmcnt(7)
    v_mfma_f32_32x32x16_bf16 v[96:111], v[112:115], v[120:123], v[96:111]
    v_perm_b32 v152, v153, v152, v158
    v_perm_b32 v153, v154, v153, v158
    v_perm_b32 v154, v155, v154, v158
    v_perm_b32 v155, v156, v155, v158
    ds_write_b128 v159, v[152:155]
    ds_read2_b32 v[112:113], v160 offset0:0 offset1:1
    ds_read2_b32 v[114:115], v160 offset0:2 offset1:3
    ds_read_b128 v[120:123], v161 offset:112
    v_add_u32 v163, 16, v157
    buffer_load_dwordx4 v[152:155], v157, s[40:43], 0 offen
    buffer_load_dword v156, v163, s[40:43], 0 offen
    v_add_u32 v157, 448, v157
    v_exp_f32 v14, v14
    v_exp_f32 v15, v15
    v_cvt_pk_bf16_f32 v42, v12, v13
    v_exp_f32 v16, v16
    s_waitcnt lgkmcnt(9)
    v_mfma_f32_32x32x8_bf16 v[24:39], v[68:69], v[84:85], v[24:39]
    ds_read_b32 v68, v87 offset:27840
    v_cvt_pk_bf16_f32 v43, v14, v15
    v_exp_f32 v17, v17
    v_exp_f32 v18, v18
    v_exp_f32 v19, v19
    v_mfma_f32_32x32x16_bf16 v[48:63], v[72:75], v[40:43], v[48:63]
    ds_read_b128 v[72:75], v88 offset:25520
    v_cvt_pk_bf16_f32 v44, v16, v17
    v_exp_f32 v20, v20
    v_exp_f32 v21, v21
    v_cvt_pk_bf16_f32 v45, v18, v19
    s_waitcnt lgkmcnt(8)
    v_mfma_f32_32x32x16_bf16 v[96:111], v[116:119], v[124:127], v[96:111]
    ds_read2_b32 v[116:117], v160 offset0:8 offset1:9
    ds_read2_b32 v[118:119], v160 offset0:10 offset1:11
    ds_read_b128 v[124:127], v161 offset:2160
    v_exp_f32 v22, v22
    v_exp_f32 v23, v23
    v_cvt_pk_bf16_f32 v46, v20, v21
    v_cvt_pk_bf16_f32 v47, v22, v23
    s_waitcnt lgkmcnt(9)
    v_mfma_f32_32x32x16_bf16 v[8:23], v[64:67], v[80:83], 0
    ds_read_b128 v[64:67], v86 offset:30160
    v_exp_f32 v24, v24
    v_exp_f32 v25, v25
    v_exp_f32 v26, v26
    v_mfma_f32_32x32x16_bf16 v[48:63], v[76:79], v[44:47], v[48:63]
    ds_read_b128 v[76:79], v89 offset:25520
    v_exp_f32 v27, v27
    v_cvt_pk_bf16_f32 v40, v24, v25
    v_exp_f32 v28, v28
    v_cvt_pk_bf16_f32 v41, v26, v27
    v_exp_f32 v29, v29
    s_waitcnt lgkmcnt(7)
    v_mfma_f32_32x32x16_bf16 v[96:111], v[112:115], v[120:123], v[96:111]
    ds_read2_b32 v[112:113], v160 offset0:16 offset1:17
    ds_read2_b32 v[114:115], v160 offset0:18 offset1:19
    ds_read_b128 v[120:123], v161 offset:128
    v_exp_f32 v30, v30
    v_exp_f32 v31, v31
    v_cvt_pk_bf16_f32 v42, v28, v29
    v_exp_f32 v32, v32
    s_waitcnt lgkmcnt(8)
    v_mfma_f32_32x32x8_bf16 v[8:23], v[68:69], v[84:85], v[8:23]
    ds_read_b32 v68, v87 offset:30160
    v_cvt_pk_bf16_f32 v43, v30, v31
    v_exp_f32 v33, v33
    v_exp_f32 v34, v34
    v_exp_f32 v35, v35
    v_mfma_f32_32x32x16_bf16 v[48:63], v[72:75], v[40:43], v[48:63]
    ds_read_b128 v[72:75], v88 offset:27840
    v_cvt_pk_bf16_f32 v44, v32, v33
    v_exp_f32 v36, v36
    v_exp_f32 v37, v37
    v_cvt_pk_bf16_f32 v45, v34, v35
    s_waitcnt lgkmcnt(7)
    v_mfma_f32_32x32x16_bf16 v[96:111], v[116:119], v[124:127], v[96:111]
    ds_read2_b32 v[116:117], v160 offset0:24 offset1:25
    ds_read2_b32 v[118:119], v160 offset0:26 offset1:27
    ds_read_b128 v[124:127], v161 offset:2176
    v_exp_f32 v38, v38
    v_exp_f32 v39, v39
    v_cvt_pk_bf16_f32 v46, v36, v37
    v_cvt_pk_bf16_f32 v47, v38, v39
    s_bitcmp1_b32 s95, 2
    s_cbranch_scc0 L_pr106
    s_setprio 0
L_pr106:
    s_waitcnt lgkmcnt(8)
    v_mfma_f32_32x32x16_bf16 v[24:39], v[64:67], v[80:83], 0
    ds_read_b128 v[64:67], v86 offset:32480
    v_exp_f32 v8, v8
    v_exp_f32 v9, v9
    v_exp_f32 v10, v10
    v_mfma_f32_32x32x16_bf16 v[48:63], v[76:79], v[44:47], v[48:63]
    ds_read_b128 v[76:79], v89 offset:27840
    v_exp_f32 v11, v11
    v_cvt_pk_bf16_f32 v40, v8, v9
    v_exp_f32 v12, v12
    v_cvt_pk_bf16_f32 v41, v10, v11
    v_exp_f32 v13, v13
    s_waitcnt lgkmcnt(7)
    v_mfma_f32_32x32x16_bf16 v[96:111], v[112:115], v[120:123], v[96:111]
    ds_read2_b32 v[112:113], v160 offset0:32 offset1:33
    ds_read2_b32 v[114:115], v160 offset0:34 offset1:35
    ds_read_b128 v[120:123], v161 offset:144
    v_exp_f32 v14, v14
    v_exp_f32 v15, v15
    v_cvt_pk_bf16_f32 v42, v12, v13
    v_exp_f32 v16, v16
    s_waitcnt lgkmcnt(8)
    v_mfma_f32_32x32x8_bf16 v[24:39], v[68:69], v[84:85], v[24:39]
    ds_read_b32 v68, v87 offset:32480
    v_cvt_pk_bf16_f32 v43, v14, v15
    v_exp_f32 v17, v17
    v_exp_f32 v18, v18
    v_exp_f32 v19, v19
    v_mfma_f32_32x32x16_bf16 v[48:63], v[72:75], v[40:43], v[48:63]
    ds_read_b128 v[72:75], v88 offset:30160
    v_cvt_pk_bf16_f32 v44, v16, v17
    v_exp_f32 v20, v20
    v_exp_f32 v21, v21
    v_cvt_pk_bf16_f32 v45, v18, v19
    s_waitcnt lgkmcnt(7)
    v_mfma_f32_32x32x16_bf16 v[96:111], v[116:119], v[124:127], v[96:111]
    ds_read2_b32 v[116:117], v160 offset0:40 offset1:41
    ds_read2_b32 v[118:119], v160 offset0:42 offset1:43
    ds_read_b128 v[124:127], v161 offset:2192
    v_exp_f32 v22, v22
    v_exp_f32 v23, v23
    v_cvt_pk_bf16_f32 v46, v20, v21
    v_cvt_pk_bf16_f32 v47, v22, v23
    s_waitcnt lgkmcnt(8)
    v_mfma_f32_32x32x16_bf16 v[8:23], v[64:67], v[80:83], 0
    ds_read_b128 v[64:67], v86 offset:34800
    v_exp_f32 v24, v24
    v_exp_f32 v25, v25
    v_exp_f32 v26, v26
    v_mfma_f32_32x32x16_bf16 v[48:63], v[76:79], v[44:47], v[48:63]
    ds_read_b128 v[76:79], v89 offset:30160
    v_exp_f32 v27, v27
    v_cvt_pk_bf16_f32 v40, v24, v25
    v_exp_f32 v28, v28
    v_cvt_pk_bf16_f32 v41, v26, v27
    v_exp_f32 v29, v29
    s_waitcnt lgkmcnt(7)
    v_mfma_f32_32x32x16_bf16 v[96:111], v[112:115], v[120:123], v[96:111]
    ds_read2_b32 v[112:113], v160 offset0:48 offset1:49
    ds_read2_b32 v[114:115], v160 offset0:50 offset1:51
    ds_read_b128 v[120:123], v161 offset:160
    v_exp_f32 v30, v30
    v_exp_f32 v31, v31
    v_cvt_pk_bf16_f32 v42, v28, v29
    v_exp_f32 v32, v32
    s_waitcnt lgkmcnt(8)
    v_mfma_f32_32x32x8_bf16 v[8:23], v[68:69], v[84:85], v[8:23]
    ds_read_b32 v68, v87 offset:34800
    v_cvt_pk_bf16_f32 v43, v30, v31
    v_exp_f32 v33, v33
    v_exp_f32 v34, v34
    v_exp_f32 v35, v35
    v_mfma_f32_32x32x16_bf16 v[48:63], v[72:75], v[40:43], v[48:63]
    ds_read_b128 v[72:75], v88 offset:32480
    v_cvt_pk_bf16_f32 v44, v32, v33
    v_exp_f32 v36, v36
    v_exp_f32 v37, v37
    v_cvt_pk_bf16_f32 v45, v34, v35
    s_waitcnt lgkmcnt(7)
    v_mfma_f32_32x32x16_bf16 v[96:111], v[116:119], v[124:127], v[96:111]
    ds_read2_b32 v[116:117], v160 offset0:56 offset1:57
    ds_read2_b32 v[118:119], v160 offset0:58 offset1:59
    ds_read_b128 v[124:127], v161 offset:2208
    v_exp_f32 v38, v38
    v_exp_f32 v39, v39
    v_cvt_pk_bf16_f32 v46, v36, v37
    v_cvt_pk_bf16_f32 v47, v38, v39
    s_waitcnt lgkmcnt(8)
    v_mfma_f32_32x32x16_bf16 v[24:39], v[64:67], v[80:83], 0
    ds_read_b128 v[64:67], v86 offset:37120
    v_exp_f32 v8, v8
    v_exp_f32 v9, v9
    v_exp_f32 v10, v10
    v_mfma_f32_32x32x16_bf16 v[48:63], v[76:79], v[44:47], v[48:63]
    ds_read_b128 v[76:79], v89 offset:32480
    v_exp_f32 v11, v11
    v_cvt_pk_bf16_f32 v40, v8, v9
    v_exp_f32 v12, v12
    v_cvt_pk_bf16_f32 v41, v10, v11
    v_exp_f32 v13, v13
    s_waitcnt lgkmcnt(7)
    v_mfma_f32_32x32x16_bf16 v[96:111], v[112:115], v[120:123], v[96:111]
    ds_read2_b32 v[112:113], v160 offset0:64 offset1:65
    ds_read2_b32 v[114:115], v160 offset0:66 offset1:67
    ds_read_b128 v[120:123], v161 offset:176
    v_exp_f32 v14, v14
    v_exp_f32 v15, v15
    v_cvt_pk_bf16_f32 v42, v12, v13
    v_exp_f32 v16, v16
    s_waitcnt lgkmcnt(8)
    v_mfma_f32_32x32x8_bf16 v[24:39], v[68:69], v[84:85], v[24:39]
    ds_read_b32 v68, v87 offset:37120
    v_cvt_pk_bf16_f32 v43, v14, v15
    v_exp_f32 v17, v17
    v_exp_f32 v18, v18
    v_exp_f32 v19, v19
    v_mfma_f32_32x32x16_bf16 v[48:63], v[72:75], v[40:43], v[48:63]
    ds_read_b128 v[72:75], v88 offset:34800
    v_cvt_pk_bf16_f32 v44, v16, v17
    v_exp_f32 v20, v20
    v_exp_f32 v21, v21
    v_cvt_pk_bf16_f32 v45, v18, v19
    s_waitcnt lgkmcnt(7)
    v_mfma_f32_32x32x16_bf16 v[96:111], v[116:119], v[124:127], v[96:111]
    ds_read2_b32 v[116:117], v160 offset0:72 offset1:73
    ds_read2_b32 v[118:119], v160 offset0:74 offset1:75
    ds_read_b128 v[124:127], v161 offset:2224
    v_exp_f32 v22, v22
    v_exp_f32 v23, v23
    v_cvt_pk_bf16_f32 v46, v20, v21
    v_cvt_pk_bf16_f32 v47, v22, v23
    s_waitcnt lgkmcnt(8)
    v_mfma_f32_32x32x16_bf16 v[8:23], v[64:67], v[80:83], 0
    ds_read_b128 v[64:67], v86 offset:39440
    v_exp_f32 v24, v24
    v_exp_f32 v25, v25
    v_exp_f32 v26, v26
    v_mfma_f32_32x32x16_bf16 v[48:63], v[76:79], v[44:47], v[48:63]
    ds_read_b128 v[76:79], v89 offset:34800
    v_exp_f32 v27, v27
    v_cvt_pk_bf16_f32 v40, v24, v25
    v_exp_f32 v28, v28
    v_cvt_pk_bf16_f32 v41, v26, v27
    v_exp_f32 v29, v29
    s_waitcnt lgkmcnt(7)
    v_mfma_f32_32x32x16_bf16 v[96:111], v[112:115], v[120:123], v[96:111]
    ds_read2_b32 v[112:113], v160 offset0:80 offset1:81
    ds_read2_b32 v[114:115], v160 offset0:82 offset1:83
    ds_read_b128 v[120:123], v161 offset:192
    v_exp_f32 v30, v30
    v_exp_f32 v31, v31
    v_cvt_pk_bf16_f32 v42, v28, v29
    v_exp_f32 v32, v32
    s_waitcnt lgkmcnt(8)
    v_mfma_f32_32x32x8_bf16 v[8:23], v[68:69], v[84:85], v[8:23]
    ds_read_b32 v68, v87 offset:39440
    v_cvt_pk_bf16_f32 v43, v30, v31
    v_exp_f32 v33, v33
    v_exp_f32 v34, v34
    v_exp_f32 v35, v35
    v_mfma_f32_32x32x16_bf16 v[48:63], v[72:75], v[40:43], v[48:63]
    ds_read_b128 v[72:75], v88 offset:37120
    v_cvt_pk_bf16_f32 v44, v32, v33
    v_exp_f32 v36, v36
    v_exp_f32 v37, v37
    v_cvt_pk_bf16_f32 v45, v34, v35
    s_waitcnt lgkmcnt(7)
    v_mfma_f32_32x32x16_bf16 v[96:111], v[116:119], v[124:127], v[96:111]
    ds_read2_b32 v[116:117], v160 offset0:88 offset1:89
    ds_read2_b32 v[118:119], v160 offset0:90 offset1:91
    ds_read_b128 v[124:127], v161 offset:2240
    v_exp_f32 v38, v38
    v_exp_f32 v39, v39
    v_cvt_pk_bf16_f32 v46, v36, v37
    v_cvt_pk_bf16_f32 v47, v38, v39
    v_add_u32 v86, 37120, v86
    v_add_u32 v87, 37120, v87
    v_add_u32 v88, 37120, v88
    v_add_u32 v89, 37120, v89
    s_bitcmp1_b32 s95, 2
    s_cbranch_scc0 L_pr107
    s_setprio 1
L_pr107:
    s_waitcnt lgkmcnt(8)
    v_mfma_f32_32x32x16_bf16 v[24:39], v[64:67], v[80:83], 0
    ds_read_b128 v[64:67], v86 offset:4640
    v_exp_f32 v8, v8
    v_exp_f32 v9, v9
    v_exp_f32 v10, v10
    v_mfma_f32_32x32x16_bf16 v[48:63], v[76:79], v[44:47], v[48:63]
    ds_read_b128 v[76:79], v89 offset:0
    v_exp_f32 v11, v11
    v_cvt_pk_bf16_f32 v40, v8, v9
    v_exp_f32 v12, v12
    v_cvt_pk_bf16_f32 v41, v10, v11
    v_exp_f32 v13, v13
    s_waitcnt lgkmcnt(7)
    v_mfma_f32_32x32x16_bf16 v[96:111], v[112:115], v[120:123], v[96:111]
    ds_read2_b32 v[112:113], v160 offset0:96 offset1:97
    ds_read2_b32 v[114:115], v160 offset0:98 offset1:99
    ds_read_b128 v[120:123], v161 offset:208
    v_exp_f32 v14, v14
    v_exp_f32 v15, v15
    v_cvt_pk_bf16_f32 v42, v12, v13
    v_exp_f32 v16, v16
    s_waitcnt lgkmcnt(8)
    v_mfma_f32_32x32x8_bf16 v[24:39], v[68:69], v[84:85], v[24:39]
    ds_read_b32 v68, v87 offset:4640
    v_cvt_pk_bf16_f32 v43, v14, v15
    v_exp_f32 v17, v17
    v_exp_f32 v18, v18
    v_exp_f32 v19, v19
    v_mfma_f32_32x32x16_bf16 v[48:63], v[72:75], v[40:43], v[48:63]
    ds_read_b128 v[72:75], v88 offset:2320
    v_cvt_pk_bf16_f32 v44, v16, v17
    v_exp_f32 v20, v20
    v_exp_f32 v21, v21
    v_cvt_pk_bf16_f32 v45, v18, v19
    s_waitcnt lgkmcnt(7)
    v_mfma_f32_32x32x16_bf16 v[96:111], v[116:119], v[124:127], v[96:111]
    ds_read2_b32 v[116:117], v160 offset0:104 offset1:105
    ds_read2_b32 v[118:119], v160 offset0:106 offset1:107
    ds_read_b128 v[124:127], v161 offset:2256
    v_exp_f32 v22, v22
    v_exp_f32 v23, v23
    v_cvt_pk_bf16_f32 v46, v20, v21
    v_cvt_pk_bf16_f32 v47, v22, v23
    s_waitcnt lgkmcnt(8)
    v_mfma_f32_32x32x16_bf16 v[8:23], v[64:67], v[80:83], 0
    ds_read_b128 v[64:67], v86 offset:6960
    v_exp_f32 v24, v24
    v_exp_f32 v25, v25
    v_exp_f32 v26, v26
    v_mfma_f32_32x32x16_bf16 v[48:63], v[76:79], v[44:47], v[48:63]
    ds_read_b128 v[76:79], v89 offset:2320
    v_exp_f32 v27, v27
    v_cvt_pk_bf16_f32 v40, v24, v25
    v_exp_f32 v28, v28
    v_cvt_pk_bf16_f32 v41, v26, v27
    v_exp_f32 v29, v29
    s_waitcnt vmcnt(0) lgkmcnt(7)
    v_mfma_f32_32x32x16_bf16 v[96:111], v[112:115], v[120:123], v[96:111]
    v_perm_b32 v152, v153, v152, v158
    v_perm_b32 v153, v154, v153, v158
    v_perm_b32 v154, v155, v154, v158
    v_perm_b32 v155, v156, v155, v158
    ds_write_b128 v159, v[152:155]
    ds_read2_b32 v[112:113], v160 offset0:0 offset1:1
    ds_read2_b32 v[114:115], v160 offset0:2 offset1:3
    ds_read_b128 v[120:123], v161 offset:224
    v_add_u32 v163, 16, v157
    buffer_load_dwordx4 v[152:155], v157, s[40:43], 0 offen
    buffer_load_dword v156, v163, s[40:43], 0 offen
    v_add_u32 v157, 448, v157
    v_exp_f32 v30, v30
    v_exp_f32 v31, v31
    v_cvt_pk_bf16_f32 v42, v28, v29
    v_exp_f32 v32, v32
    s_waitcnt lgkmcnt(9)
    v_mfma_f32_32x32x8_bf16 v[8:23], v[68:69], v[84:85], v[8:23]
    ds_read_b32 v68, v87 offset:6960
    v_cvt_pk_bf16_f32 v43, v30, v31
    v_exp_f32 v33, v33
    v_exp_f32 v34, v34
    v_exp_f32 v35, v35
    v_mfma_f32_32x32x16_bf16 v[48:63], v[72:75], v[40:43], v[48:63]
    ds_read_b128 v[72:75], v88 offset:4640
    v_cvt_pk_bf16_f32 v44, v32, v33
    v_exp_f32 v36, v36
    v_exp_f32 v37, v37
    v_cvt_pk_bf16_f32 v45, v34, v35
    s_waitcnt lgkmcnt(8)
    v_mfma_f32_32x32x16_bf16 v[96:111], v[116:119], v[124:127], v[96:111]
    ds_read2_b32 v[116:117], v160 offset0:8 offset1:9
    ds_read2_b32 v[118:119], v160 offset0:10 offset1:11
    ds_read_b128 v[124:127], v161 offset:2272
    v_exp_f32 v38, v38
    v_exp_f32 v39, v39
    v_cvt_pk_bf16_f32 v46, v36, v37
    v_cvt_pk_bf16_f32 v47, v38, v39
    s_waitcnt lgkmcnt(9)
    v_mfma_f32_32x32x16_bf16 v[24:39], v[64:67], v[80:83], 0
    ds_read_b128 v[64:67], v86 offset:9280
    v_exp_f32 v8, v8
    v_exp_f32 v9, v9
    v_exp_f32 v10, v10
    v_mfma_f32_32x32x16_bf16 v[48:63], v[76:79], v[44:47], v[48:63]
    ds_read_b128 v[76:79], v89 offset:4640
    v_exp_f32 v11, v11
    v_cvt_pk_bf16_f32 v40, v8, v9
    v_exp_f32 v12, v12
    v_cvt_pk_bf16_f32 v41, v10, v11
    v_exp_f32 v13, v13
    s_waitcnt lgkmcnt(7)
    v_mfma_f32_32x32x16_bf16 v[96:111], v[112:115], v[120:123], v[96:111]
    ds_read2_b32 v[112:113], v160 offset0:16 offset1:17
    ds_read2_b32 v[114:115], v160 offset0:18 offset1:19
    ds_read_b128 v[120:123], v161 offset:240
    v_exp_f32 v14, v14
    v_exp_f32 v15, v15
    v_cvt_pk_bf16_f32 v42, v12, v13
    v_exp_f32 v16, v16
    s_waitcnt lgkmcnt(8)
    v_mfma_f32_32x32x8_bf16 v[24:39], v[68:69], v[84:85], v[24:39]
    ds_read_b32 v68, v87 offset:9280
    v_cvt_pk_bf16_f32 v43, v14, v15
    v_exp_f32 v17, v17
    v_exp_f32 v18, v18
    v_exp_f32 v19, v19
    v_mfma_f32_32x32x16_bf16 v[48:63], v[72:75], v[40:43], v[48:63]
    ds_read_b128 v[72:75], v88 offset:6960
    v_cvt_pk_bf16_f32 v44, v16, v17
    v_exp_f32 v20, v20
    v_exp_f32 v21, v21
    v_cvt_pk_bf16_f32 v45, v18, v19
    s_waitcnt lgkmcnt(7)
    v_mfma_f32_32x32x16_bf16 v[96:111], v[116:119], v[124:127], v[96:111]
    ds_read2_b32 v[116:117], v160 offset0:24 offset1:25
    ds_read2_b32 v[118:119], v160 offset0:26 offset1:27
    ds_read_b128 v[124:127], v161 offset:2288
    v_exp_f32 v22, v22
    v_exp_f32 v23, v23
    v_cvt_pk_bf16_f32 v46, v20, v21
    v_cvt_pk_bf16_f32 v47, v22, v23
    s_waitcnt lgkmcnt(8)
    v_mfma_f32_32x32x16_bf16 v[8:23], v[64:67], v[80:83], 0
    ds_read_b128 v[64:67], v86 offset:11600
    v_exp_f32 v24, v24
    v_exp_f32 v25, v25
    v_exp_f32 v26, v26
    v_mfma_f32_32x32x16_bf16 v[48:63], v[76:79], v[44:47], v[48:63]
    ds_read_b128 v[76:79], v89 offset:6960
    v_exp_f32 v27, v27
    v_cvt_pk_bf16_f32 v40, v24, v25
    v_exp_f32 v28, v28
    v_cvt_pk_bf16_f32 v41, v26, v27
    v_exp_f32 v29, v29
    s_waitcnt lgkmcnt(7)
    v_mfma_f32_32x32x16_bf16 v[96:111], v[112:115], v[120:123], v[96:111]
    ds_read2_b32 v[112:113], v160 offset0:32 offset1:33
    ds_read2_b32 v[114:115], v160 offset0:34 offset1:35
    ds_read_b128 v[120:123], v161 offset:256
    v_exp_f32 v30, v30
    v_exp_f32 v31, v31
    v_cvt_pk_bf16_f32 v42, v28, v29
    v_exp_f32 v32, v32
    s_waitcnt lgkmcnt(8)
    v_mfma_f32_32x32x8_bf16 v[8:23], v[68:69], v[84:85], v[8:23]
    ds_read_b32 v68, v87 offset:11600
    v_cvt_pk_bf16_f32 v43, v30, v31
    v_exp_f32 v33, v33
    v_exp_f32 v34, v34
    v_exp_f32 v35, v35
    v_mfma_f32_32x32x16_bf16 v[48:63], v[72:75], v[40:43], v[48:63]
    ds_read_b128 v[72:75], v88 offset:9280
    v_cvt_pk_bf16_f32 v44, v32, v33
    v_exp_f32 v36, v36
    v_exp_f32 v37, v37
    v_cvt_pk_bf16_f32 v45, v34, v35
    s_waitcnt lgkmcnt(7)
    v_mfma_f32_32x32x16_bf16 v[96:111], v[116:119], v[124:127], v[96:111]
    ds_read2_b32 v[116:117], v160 offset0:40 offset1:41
    ds_read2_b32 v[118:119], v160 offset0:42 offset1:43
    ds_read_b128 v[124:127], v161 offset:2304
    v_exp_f32 v38, v38
    v_exp_f32 v39, v39
    v_cvt_pk_bf16_f32 v46, v36, v37
    v_cvt_pk_bf16_f32 v47, v38, v39
    s_waitcnt lgkmcnt(8)
    v_mfma_f32_32x32x16_bf16 v[24:39], v[64:67], v[80:83], 0
    ds_read_b128 v[64:67], v86 offset:13920
    v_exp_f32 v8, v8
    v_exp_f32 v9, v9
    v_exp_f32 v10, v10
    v_mfma_f32_32x32x16_bf16 v[48:63], v[76:79], v[44:47], v[48:63]
    ds_read_b128 v[76:79], v89 offset:9280
    v_exp_f32 v11, v11
    v_cvt_pk_bf16_f32 v40, v8, v9
    v_exp_f32 v12, v12
    v_cvt_pk_bf16_f32 v41, v10, v11
    v_exp_f32 v13, v13
    s_waitcnt lgkmcnt(7)
    v_mfma_f32_32x32x16_bf16 v[96:111], v[112:115], v[120:123], v[96:111]
    ds_read2_b32 v[112:113], v160 offset0:48 offset1:49
    ds_read2_b32 v[114:115], v160 offset0:50 offset1:51
    ds_read_b128 v[120:123], v161 offset:272
    v_exp_f32 v14, v14
    v_exp_f32 v15, v15
    v_cvt_pk_bf16_f32 v42, v12, v13
    v_exp_f32 v16, v16
    s_waitcnt lgkmcnt(8)
    v_mfma_f32_32x32x8_bf16 v[24:39], v[68:69], v[84:85], v[24:39]
    ds_read_b32 v68, v87 offset:13920
    v_cvt_pk_bf16_f32 v43, v14, v15
    v_exp_f32 v17, v17
    v_exp_f32 v18, v18
    v_exp_f32 v19, v19
    v_mfma_f32_32x32x16_bf16 v[48:63], v[72:75], v[40:43], v[48:63]
    ds_read_b128 v[72:75], v88 offset:11600
    v_cvt_pk_bf16_f32 v44, v16, v17
    v_exp_f32 v20, v20
    v_exp_f32 v21, v21
    v_cvt_pk_bf16_f32 v45, v18, v19
    s_waitcnt lgkmcnt(7)
    v_mfma_f32_32x32x16_bf16 v[96:111], v[116:119], v[124:127], v[96:111]
    ds_read2_b32 v[116:117], v160 offset0:56 offset1:57
    ds_read2_b32 v[118:119], v160 offset0:58 offset1:59
    ds_read_b128 v[124:127], v161 offset:2320
    v_exp_f32 v22, v22
    v_exp_f32 v23, v23
    v_cvt_pk_bf16_f32 v46, v20, v21
    v_cvt_pk_bf16_f32 v47, v22, v23
    s_bitcmp1_b32 s95, 2
    s_cbranch_scc0 L_pr108
    s_setprio 0
L_pr108:
    s_waitcnt lgkmcnt(8)
    v_mfma_f32_32x32x16_bf16 v[8:23], v[64:67], v[80:83], 0
    ds_read_b128 v[64:67], v86 offset:16240
    v_exp_f32 v24, v24
    v_exp_f32 v25, v25
    v_exp_f32 v26, v26
    v_mfma_f32_32x32x16_bf16 v[48:63], v[76:79], v[44:47], v[48:63]
    ds_read_b128 v[76:79], v89 offset:11600
    v_exp_f32 v27, v27
    v_cvt_pk_bf16_f32 v40, v24, v25
    v_exp_f32 v28, v28
    v_cvt_pk_bf16_f32 v41, v26, v27
    v_exp_f32 v29, v29
    s_waitcnt lgkmcnt(7)
    v_mfma_f32_32x32x16_bf16 v[96:111], v[112:115], v[120:123], v[96:111]
    ds_read2_b32 v[112:113], v160 offset0:64 offset1:65
    ds_read2_b32 v[114:115], v160 offset0:66 offset1:67
    ds_read_b128 v[120:123], v161 offset:288
    v_exp_f32 v30, v30
    v_exp_f32 v31, v31
    v_cvt_pk_bf16_f32 v42, v28, v29
    v_exp_f32 v32, v32
    s_waitcnt lgkmcnt(8)
    v_mfma_f32_32x32x8_bf16 v[8:23], v[68:69], v[84:85], v[8:23]
    ds_read_b32 v68, v87 offset:16240
    v_cvt_pk_bf16_f32 v43, v30, v31
    v_exp_f32 v33, v33
    v_exp_f32 v34, v34
    v_exp_f32 v35, v35
    v_mfma_f32_32x32x16_bf16 v[48:63], v[72:75], v[40:43], v[48:63]
    ds_read_b128 v[72:75], v88 offset:13920
    v_cvt_pk_bf16_f32 v44, v32, v33
    v_exp_f32 v36, v36
    v_exp_f32 v37, v37
    v_cvt_pk_bf16_f32 v45, v34, v35
    s_waitcnt lgkmcnt(7)
    v_mfma_f32_32x32x16_bf16 v[96:111], v[116:119], v[124:127], v[96:111]
    ds_read2_b32 v[116:117], v160 offset0:72 offset1:73
    ds_read2_b32 v[118:119], v160 offset0:74 offset1:75
    ds_read_b128 v[124:127], v161 offset:2336
    v_exp_f32 v38, v38
    v_exp_f32 v39, v39
    v_cvt_pk_bf16_f32 v46, v36, v37
    v_cvt_pk_bf16_f32 v47, v38, v39
    s_waitcnt lgkmcnt(8)
    v_mfma_f32_32x32x16_bf16 v[24:39], v[64:67], v[80:83], 0
    ds_read_b128 v[64:67], v86 offset:18560
    v_exp_f32 v8, v8
    v_exp_f32 v9, v9
    v_exp_f32 v10, v10
    v_mfma_f32_32x32x16_bf16 v[48:63], v[76:79], v[44:47], v[48:63]
    ds_read_b128 v[76:79], v89 offset:13920
    v_exp_f32 v11, v11
    v_cvt_pk_bf16_f32 v40, v8, v9
    v_exp_f32 v12, v12
    v_cvt_pk_bf16_f32 v41, v10, v11
    v_exp_f32 v13, v13
    s_waitcnt lgkmcnt(7)
    v_mfma_f32_32x32x16_bf16 v[96:111], v[112:115], v[120:123], v[96:111]
    ds_read2_b32 v[112:113], v160 offset0:80 offset1:81
    ds_read2_b32 v[114:115], v160 offset0:82 offset1:83
    ds_read_b128 v[120:123], v161 offset:304
    v_exp_f32 v14, v14
    v_exp_f32 v15, v15
    v_cvt_pk_bf16_f32 v42, v12, v13
    v_exp_f32 v16, v16
    s_waitcnt lgkmcnt(8)
    v_mfma_f32_32x32x8_bf16 v[24:39], v[68:69], v[84:85], v[24:39]
    ds_read_b32 v68, v87 offset:18560
    v_cvt_pk_bf16_f32 v43, v14, v15
    v_exp_f32 v17, v17
    v_exp_f32 v18, v18
    v_exp_f32 v19, v19
    v_mfma_f32_32x32x16_bf16 v[48:63], v[72:75], v[40:43], v[48:63]
    ds_read_b128 v[72:75], v88 offset:16240
    v_cvt_pk_bf16_f32 v44, v16, v17
    v_exp_f32 v20, v20
    v_exp_f32 v21, v21
    v_cvt_pk_bf16_f32 v45, v18, v19
    s_waitcnt lgkmcnt(7)
    v_mfma_f32_32x32x16_bf16 v[96:111], v[116:119], v[124:127], v[96:111]
    ds_read2_b32 v[116:117], v160 offset0:88 offset1:89
    ds_read2_b32 v[118:119], v160 offset0:90 offset1:91
    ds_read_b128 v[124:127], v161 offset:2352
    v_exp_f32 v22, v22
    v_exp_f32 v23, v23
    v_cvt_pk_bf16_f32 v46, v20, v21
    v_cvt_pk_bf16_f32 v47, v22, v23
    s_waitcnt lgkmcnt(8)
    v_mfma_f32_32x32x16_bf16 v[8:23], v[64:67], v[80:83], 0
    ds_read_b128 v[64:67], v86 offset:20880
    v_exp_f32 v24, v24
    v_exp_f32 v25, v25
    v_exp_f32 v26, v26
    v_mfma_f32_32x32x16_bf16 v[48:63], v[76:79], v[44:47], v[48:63]
    ds_read_b128 v[76:79], v89 offset:16240
    v_exp_f32 v27, v27
    v_cvt_pk_bf16_f32 v40, v24, v25
    v_exp_f32 v28, v28
    v_cvt_pk_bf16_f32 v41, v26, v27
    v_exp_f32 v29, v29
    s_waitcnt lgkmcnt(7)
    v_mfma_f32_32x32x16_bf16 v[96:111], v[112:115], v[120:123], v[96:111]
    ds_read2_b32 v[112:113], v160 offset0:96 offset1:97
    ds_read2_b32 v[114:115], v160 offset0:98 offset1:99
    ds_read_b128 v[120:123], v161 offset:320
    v_exp_f32 v30, v30
    v_exp_f32 v31, v31
    v_cvt_pk_bf16_f32 v42, v28, v29
    v_exp_f32 v32, v32
    s_waitcnt lgkmcnt(8)
    v_mfma_f32_32x32x8_bf16 v[8:23], v[68:69], v[84:85], v[8:23]
    ds_read_b32 v68, v87 offset:20880
    v_cvt_pk_bf16_f32 v43, v30, v31
    v_exp_f32 v33, v33
    v_exp_f32 v34, v34
    v_exp_f32 v35, v35
    v_mfma_f32_32x32x16_bf16 v[48:63], v[72:75], v[40:43], v[48:63]
    ds_read_b128 v[72:75], v88 offset:18560
    v_cvt_pk_bf16_f32 v44, v32, v33
    v_exp_f32 v36, v36
    v_exp_f32 v37, v37
    v_cvt_pk_bf16_f32 v45, v34, v35
    s_waitcnt lgkmcnt(7)
    v_mfma_f32_32x32x16_bf16 v[96:111], v[116:119], v[124:127], v[96:111]
    ds_read2_b32 v[116:117], v160 offset0:104 offset1:105
    ds_read2_b32 v[118:119], v160 offset0:106 offset1:107
    ds_read_b128 v[124:127], v161 offset:2368
    v_exp_f32 v38, v38
    v_exp_f32 v39, v39
    v_cvt_pk_bf16_f32 v46, v36, v37
    v_cvt_pk_bf16_f32 v47, v38, v39
    v_mov_b32 v91, 157212
    s_mov_b64 exec, 1
    ds_add_u32 v91, v92
    s_mov_b64 exec, -1
    s_bitcmp1_b32 s95, 2
    s_cbranch_scc0 L_pr109
    s_setprio 1
L_pr109:
    s_waitcnt lgkmcnt(9)
    v_mfma_f32_32x32x16_bf16 v[24:39], v[64:67], v[80:83], 0
    ds_read_b128 v[64:67], v86 offset:23200
    v_exp_f32 v8, v8
    v_exp_f32 v9, v9
    v_exp_f32 v10, v10
    v_mfma_f32_32x32x16_bf16 v[48:63], v[76:79], v[44:47], v[48:63]
    ds_read_b128 v[76:79], v89 offset:18560
    v_exp_f32 v11, v11
    v_cvt_pk_bf16_f32 v40, v8, v9
    v_exp_f32 v12, v12
    v_cvt_pk_bf16_f32 v41, v10, v11
    v_exp_f32 v13, v13
    s_waitcnt vmcnt(0) lgkmcnt(8)
    v_mfma_f32_32x32x16_bf16 v[96:111], v[112:115], v[120:123], v[96:111]
    v_perm_b32 v152, v153, v152, v158
    v_perm_b32 v153, v154, v153, v158
    v_perm_b32 v154, v155, v154, v158
    v_perm_b32 v155, v156, v155, v158
    ds_write_b128 v159, v[152:155]
    ds_read2_b32 v[112:113], v160 offset0:0 offset1:1
    ds_read2_b32 v[114:115], v160 offset0:2 offset1:3
    ds_read_b128 v[120:123], v161 offset:336
    v_add_u32 v163, 16, v157
    buffer_load_dwordx4 v[152:155], v157, s[40:43], 0 offen
    buffer_load_dword v156, v163, s[40:43], 0 offen
    v_add_u32 v157, 448, v157
    v_exp_f32 v14, v14
    v_exp_f32 v15, v15
    v_cvt_pk_bf16_f32 v42, v12, v13
    v_exp_f32 v16, v16
    s_waitcnt lgkmcnt(10)
    v_mfma_f32_32x32x8_bf16 v[24:39], v[68:69], v[84:85], v[24:39]
    ds_read_b32 v68, v87 offset:23200
    v_cvt_pk_bf16_f32 v43, v14, v15
    v_exp_f32 v17, v17
    v_exp_f32 v18, v18
    v_exp_f32 v19, v19
    v_mfma_f32_32x32x16_bf16 v[48:63], v[72:75], v[40:43], v[48:63]
    ds_read_b128 v[72:75], v88 offset:20880
    v_cvt_pk_bf16_f32 v44, v16, v17
    v_exp_f32 v20, v20
    v_exp_f32 v21, v21
    v_cvt_pk_bf16_f32 v45, v18, v19
    s_waitcnt lgkmcnt(9)
    v_mfma_f32_32x32x16_bf16 v[96:111], v[116:119], v[124:127], v[96:111]
    ds_read2_b32 v[116:117], v160 offset0:8 offset1:9
    ds_read2_b32 v[118:119], v160 offset0:10 offset1:11
    ds_read_b128 v[124:127], v161 offset:2384
    v_exp_f32 v22, v22
    v_exp_f32 v23, v23
    v_cvt_pk_bf16_f32 v46, v20, v21
    v_cvt_pk_bf16_f32 v47, v22, v23
    s_waitcnt lgkmcnt(9)
    v_mfma_f32_32x32x16_bf16 v[8:23], v[64:67], v[80:83], 0
    ds_read_b128 v[64:67], v86 offset:25520
    v_exp_f32 v24, v24
    v_exp_f32 v25, v25
    v_exp_f32 v26, v26
    v_mfma_f32_32x32x16_bf16 v[48:63], v[76:79], v[44:47], v[48:63]
    ds_read_b128 v[76:79], v89 offset:20880
    v_exp_f32 v27, v27
    v_cvt_pk_bf16_f32 v40, v24, v25
    v_exp_f32 v28, v28
    v_cvt_pk_bf16_f32 v41, v26, v27
    v_exp_f32 v29, v29
    s_waitcnt lgkmcnt(7)
    v_mfma_f32_32x32x16_bf16 v[96:111], v[112:115], v[120:123], v[96:111]
    ds_read2_b32 v[112:113], v160 offset0:16 offset1:17
    ds_read2_b32 v[114:115], v160 offset0:18 offset1:19
    ds_read_b128 v[120:123], v161 offset:352
    v_exp_f32 v30, v30
    v_exp_f32 v31, v31
    v_cvt_pk_bf16_f32 v42, v28, v29
    v_exp_f32 v32, v32
    s_waitcnt lgkmcnt(8)
    v_mfma_f32_32x32x8_bf16 v[8:23], v[68:69], v[84:85], v[8:23]
    ds_read_b32 v68, v87 offset:25520
    v_cvt_pk_bf16_f32 v43, v30, v31
    v_exp_f32 v33, v33
    v_exp_f32 v34, v34
    v_exp_f32 v35, v35
    v_mfma_f32_32x32x16_bf16 v[48:63], v[72:75], v[40:43], v[48:63]
    ds_read_b128 v[72:75], v88 offset:23200
    v_cvt_pk_bf16_f32 v44, v32, v33
    v_exp_f32 v36, v36
    v_exp_f32 v37, v37
    v_cvt_pk_bf16_f32 v45, v34, v35
    s_waitcnt lgkmcnt(7)
    v_mfma_f32_32x32x16_bf16 v[96:111], v[116:119], v[124:127], v[96:111]
    ds_read2_b32 v[116:117], v160 offset0:24 offset1:25
    ds_read2_b32 v[118:119], v160 offset0:26 offset1:27
    ds_read_b128 v[124:127], v161 offset:2400
    v_exp_f32 v38, v38
    v_exp_f32 v39, v39
    v_cvt_pk_bf16_f32 v46, v36, v37
    v_cvt_pk_bf16_f32 v47, v38, v39
    s_waitcnt lgkmcnt(8)
    v_mfma_f32_32x32x16_bf16 v[24:39], v[64:67], v[80:83], 0
    ds_read_b128 v[64:67], v86 offset:27840
    v_exp_f32 v8, v8
    v_exp_f32 v9, v9
    v_exp_f32 v10, v10
    v_mfma_f32_32x32x16_bf16 v[48:63], v[76:79], v[44:47], v[48:63]
    ds_read_b128 v[76:79], v89 offset:23200
    v_exp_f32 v11, v11
    v_cvt_pk_bf16_f32 v40, v8, v9
    v_exp_f32 v12, v12
    v_cvt_pk_bf16_f32 v41, v10, v11
    v_exp_f32 v13, v13
    s_waitcnt lgkmcnt(7)
    v_mfma_f32_32x32x16_bf16 v[96:111], v[112:115], v[120:123], v[96:111]
    ds_read2_b32 v[112:113], v160 offset0:32 offset1:33
    ds_read2_b32 v[114:115], v160 offset0:34 offset1:35
    ds_read_b128 v[120:123], v161 offset:368
    v_exp_f32 v14, v14
    v_exp_f32 v15, v15
    v_cvt_pk_bf16_f32 v42, v12, v13
    v_exp_f32 v16, v16
    s_waitcnt lgkmcnt(8)
    v_mfma_f32_32x32x8_bf16 v[24:39], v[68:69], v[84:85], v[24:39]
    ds_read_b32 v68, v87 offset:27840
    v_cvt_pk_bf16_f32 v43, v14, v15
    v_exp_f32 v17, v17
    v_exp_f32 v18, v18
    v_exp_f32 v19, v19
    v_mfma_f32_32x32x16_bf16 v[48:63], v[72:75], v[40:43], v[48:63]
    ds_read_b128 v[72:75], v88 offset:25520
    v_cvt_pk_bf16_f32 v44, v16, v17
    v_exp_f32 v20, v20
    v_exp_f32 v21, v21
    v_cvt_pk_bf16_f32 v45, v18, v19
    s_waitcnt lgkmcnt(7)
    v_mfma_f32_32x32x16_bf16 v[96:111], v[116:119], v[124:127], v[96:111]
    ds_read2_b32 v[116:117], v160 offset0:40 offset1:41
    ds_read2_b32 v[118:119], v160 offset0:42 offset1:43
    ds_read_b128 v[124:127], v161 offset:2416
    v_exp_f32 v22, v22
    v_exp_f32 v23, v23
    v_cvt_pk_bf16_f32 v46, v20, v21
    v_cvt_pk_bf16_f32 v47, v22, v23
    s_waitcnt lgkmcnt(8)
    v_mfma_f32_32x32x16_bf16 v[8:23], v[64:67], v[80:83], 0
    ds_read_b128 v[64:67], v86 offset:30160
    v_exp_f32 v24, v24
    v_exp_f32 v25, v25
    v_exp_f32 v26, v26
    v_mfma_f32_32x32x16_bf16 v[48:63], v[76:79], v[44:47], v[48:63]
    ds_read_b128 v[76:79], v89 offset:25520
    v_exp_f32 v27, v27
    v_cvt_pk_bf16_f32 v40, v24, v25
    v_exp_f32 v28, v28
    v_cvt_pk_bf16_f32 v41, v26, v27
    v_exp_f32 v29, v29
    s_waitcnt lgkmcnt(7)
    v_mfma_f32_32x32x16_bf16 v[96:111], v[112:115], v[120:123], v[96:111]
    ds_read2_b32 v[112:113], v160 offset0:48 offset1:49
    ds_read2_b32 v[114:115], v160 offset0:50 offset1:51
    ds_read_b128 v[120:123], v161 offset:384
    v_exp_f32 v30, v30
    v_exp_f32 v31, v31
    v_cvt_pk_bf16_f32 v42, v28, v29
    v_exp_f32 v32, v32
    s_waitcnt lgkmcnt(8)
    v_mfma_f32_32x32x8_bf16 v[8:23], v[68:69], v[84:85], v[8:23]
    ds_read_b32 v68, v87 offset:30160
    v_cvt_pk_bf16_f32 v43, v30, v31
    v_exp_f32 v33, v33
    v_exp_f32 v34, v34
    v_exp_f32 v35, v35
    v_mfma_f32_32x32x16_bf16 v[48:63], v[72:75], v[40:43], v[48:63]
    ds_read_b128 v[72:75], v88 offset:27840
    v_cvt_pk_bf16_f32 v44, v32, v33
    v_exp_f32 v36, v36
    v_exp_f32 v37, v37
    v_cvt_pk_bf16_f32 v45, v34, v35
    s_waitcnt lgkmcnt(7)
    v_mfma_f32_32x32x16_bf16 v[96:111], v[116:119], v[124:127], v[96:111]
    ds_read2_b32 v[116:117], v160 offset0:56 offset1:57
    ds_read2_b32 v[118:119], v160 offset0:58 offset1:59
    ds_read_b128 v[124:127], v161 offset:2432
    v_exp_f32 v38, v38
    v_exp_f32 v39, v39
    v_cvt_pk_bf16_f32 v46, v36, v37
    v_cvt_pk_bf16_f32 v47, v38, v39
    s_bitcmp1_b32 s95, 2
    s_cbranch_scc0 L_pr110
    s_setprio 0
L_pr110:
    s_waitcnt lgkmcnt(8)
    v_mfma_f32_32x32x16_bf16 v[24:39], v[64:67], v[80:83], 0
    ds_read_b128 v[64:67], v86 offset:32480
    v_exp_f32 v8, v8
    v_exp_f32 v9, v9
    v_exp_f32 v10, v10
    v_mfma_f32_32x32x16_bf16 v[48:63], v[76:79], v[44:47], v[48:63]
    ds_read_b128 v[76:79], v89 offset:27840
    v_exp_f32 v11, v11
    v_cvt_pk_bf16_f32 v40, v8, v9
    v_exp_f32 v12, v12
    v_cvt_pk_bf16_f32 v41, v10, v11
    v_exp_f32 v13, v13
    s_waitcnt lgkmcnt(7)
    v_mfma_f32_32x32x16_bf16 v[96:111], v[112:115], v[120:123], v[96:111]
    ds_read2_b32 v[112:113], v160 offset0:64 offset1:65
    ds_read2_b32 v[114:115], v160 offset0:66 offset1:67
    ds_read_b128 v[120:123], v161 offset:400
    v_exp_f32 v14, v14
    v_exp_f32 v15, v15
    v_cvt_pk_bf16_f32 v42, v12, v13
    v_exp_f32 v16, v16
    s_waitcnt lgkmcnt(8)
    v_mfma_f32_32x32x8_bf16 v[24:39], v[68:69], v[84:85], v[24:39]
    ds_read_b32 v68, v87 offset:32480
    v_cvt_pk_bf16_f32 v43, v14, v15
    v_exp_f32 v17, v17
    v_exp_f32 v18, v18
    v_exp_f32 v19, v19
    v_mfma_f32_32x32x16_bf16 v[48:63], v[72:75], v[40:43], v[48:63]
    ds_read_b128 v[72:75], v88 offset:30160
    v_cvt_pk_bf16_f32 v44, v16, v17
    v_exp_f32 v20, v20
    v_exp_f32 v21, v21
    v_cvt_pk_bf16_f32 v45, v18, v19
    s_waitcnt lgkmcnt(7)
    v_mfma_f32_32x32x16_bf16 v[96:111], v[116:119], v[124:127], v[96:111]
    ds_read2_b32 v[116:117], v160 offset0:72 offset1:73
    ds_read2_b32 v[118:119], v160 offset0:74 offset1:75
    ds_read_b128 v[124:127], v161 offset:2448
    v_exp_f32 v22, v22
    v_exp_f32 v23, v23
    v_cvt_pk_bf16_f32 v46, v20, v21
    v_cvt_pk_bf16_f32 v47, v22, v23
    s_waitcnt lgkmcnt(8)
    v_mfma_f32_32x32x16_bf16 v[8:23], v[64:67], v[80:83], 0
    ds_read_b128 v[64:67], v86 offset:34800
    v_exp_f32 v24, v24
    v_exp_f32 v25, v25
    v_exp_f32 v26, v26
    v_mfma_f32_32x32x16_bf16 v[48:63], v[76:79], v[44:47], v[48:63]
    ds_read_b128 v[76:79], v89 offset:30160
    v_exp_f32 v27, v27
    v_cvt_pk_bf16_f32 v40, v24, v25
    v_exp_f32 v28, v28
    v_cvt_pk_bf16_f32 v41, v26, v27
    v_exp_f32 v29, v29
    s_waitcnt lgkmcnt(7)
    v_mfma_f32_32x32x16_bf16 v[96:111], v[112:115], v[120:123], v[96:111]
    ds_read2_b32 v[112:113], v160 offset0:80 offset1:81
    ds_read2_b32 v[114:115], v160 offset0:82 offset1:83
    ds_read_b128 v[120:123], v161 offset:416
    v_exp_f32 v30, v30
    v_exp_f32 v31, v31
    v_cvt_pk_bf16_f32 v42, v28, v29
    v_exp_f32 v32, v32
    s_waitcnt lgkmcnt(8)
    v_mfma_f32_32x32x8_bf16 v[8:23], v[68:69], v[84:85], v[8:23]
    ds_read_b32 v68, v87 offset:34800
    v_cvt_pk_bf16_f32 v43, v30, v31
    v_exp_f32 v33, v33
    v_exp_f32 v34, v34
    v_exp_f32 v35, v35
    v_mfma_f32_32x32x16_bf16 v[48:63], v[72:75], v[40:43], v[48:63]
    ds_read_b128 v[72:75], v88 offset:32480
    v_cvt_pk_bf16_f32 v44, v32, v33
    v_exp_f32 v36, v36
    v_exp_f32 v37, v37
    v_cvt_pk_bf16_f32 v45, v34, v35
    s_waitcnt lgkmcnt(7)
    v_mfma_f32_32x32x16_bf16 v[96:111], v[116:119], v[124:127], v[96:111]
    ds_read2_b32 v[116:117], v160 offset0:88 offset1:89
    ds_read2_b32 v[118:119], v160 offset0:90 offset1:91
    ds_read_b128 v[124:127], v161 offset:2464
    v_exp_f32 v38, v38
    v_exp_f32 v39, v39
    v_cvt_pk_bf16_f32 v46, v36, v37
    v_cvt_pk_bf16_f32 v47, v38, v39
    s_waitcnt lgkmcnt(8)
    v_mfma_f32_32x32x16_bf16 v[24:39], v[64:67], v[80:83], 0
    ds_read_b128 v[64:67], v86 offset:37120
    v_exp_f32 v8, v8
    v_exp_f32 v9, v9
    v_exp_f32 v10, v10
    v_mfma_f32_32x32x16_bf16 v[48:63], v[76:79], v[44:47], v[48:63]
    ds_read_b128 v[76:79], v89 offset:32480
    v_exp_f32 v11, v11
    v_cvt_pk_bf16_f32 v40, v8, v9
    v_exp_f32 v12, v12
    v_cvt_pk_bf16_f32 v41, v10, v11
    v_exp_f32 v13, v13
    s_waitcnt lgkmcnt(7)
    v_mfma_f32_32x32x16_bf16 v[96:111], v[112:115], v[120:123], v[96:111]
    ds_read2_b32 v[112:113], v160 offset0:96 offset1:97
    ds_read2_b32 v[114:115], v160 offset0:98 offset1:99
    ds_read_b128 v[120:123], v161 offset:432
    v_exp_f32 v14, v14
    v_exp_f32 v15, v15
    v_cvt_pk_bf16_f32 v42, v12, v13
    v_exp_f32 v16, v16
    s_waitcnt lgkmcnt(8)
    v_mfma_f32_32x32x8_bf16 v[24:39], v[68:69], v[84:85], v[24:39]
    ds_read_b32 v68, v87 offset:37120
    v_cvt_pk_bf16_f32 v43, v14, v15
    v_exp_f32 v17, v17
    v_exp_f32 v18, v18
    v_exp_f32 v19, v19
    v_mfma_f32_32x32x16_bf16 v[48:63], v[72:75], v[40:43], v[48:63]
    ds_read_b128 v[72:75], v88 offset:34800
    v_cvt_pk_bf16_f32 v44, v16, v17
    v_exp_f32 v20, v20
    v_exp_f32 v21, v21
    v_cvt_pk_bf16_f32 v45, v18, v19
    s_waitcnt lgkmcnt(7)
    v_mfma_f32_32x32x16_bf16 v[96:111], v[116:119], v[124:127], v[96:111]
    ds_read2_b32 v[116:117], v160 offset0:104 offset1:105
    ds_read2_b32 v[118:119], v160 offset0:106 offset1:107
    ds_read_b128 v[124:127], v161 offset:2480
    v_exp_f32 v22, v22
    v_exp_f32 v23, v23
    v_cvt_pk_bf16_f32 v46, v20, v21
    v_cvt_pk_bf16_f32 v47, v22, v23
    s_waitcnt lgkmcnt(8)
    v_mfma_f32_32x32x16_bf16 v[8:23], v[64:67], v[80:83], 0
    ds_read_b128 v[64:67], v86 offset:39440
    v_exp_f32 v24, v24
    v_exp_f32 v25, v25
    v_exp_f32 v26, v26
    v_mfma_f32_32x32x16_bf16 v[48:63], v[76:79], v[44:47], v[48:63]
    ds_read_b128 v[76:79], v89 offset:34800
    v_exp_f32 v27, v27
    v_cvt_pk_bf16_f32 v40, v24, v25
    v_exp_f32 v28, v28
    v_cvt_pk_bf16_f32 v41, v26, v27
    v_exp_f32 v29, v29
    s_waitcnt vmcnt(0) lgkmcnt(7)
    v_mfma_f32_32x32x16_bf16 v[96:111], v[112:115], v[120:123], v[96:111]
    v_perm_b32 v152, v153, v152, v158
    v_perm_b32 v153, v154, v153, v158
    v_perm_b32 v154, v155, v154, v158
    v_perm_b32 v155, v156, v155, v158
    ds_write_b128 v159, v[152:155]
    ds_read2_b32 v[112:113], v160 offset0:0 offset1:1
    ds_read2_b32 v[114:115], v160 offset0:2 offset1:3
    ds_read_b128 v[120:123], v161 offset:448
    v_exp_f32 v30, v30
    v_exp_f32 v31, v31
    v_cvt_pk_bf16_f32 v42, v28, v29
    v_exp_f32 v32, v32
    s_waitcnt lgkmcnt(9)
    v_mfma_f32_32x32x8_bf16 v[8:23], v[68:69], v[84:85], v[8:23]
    ds_read_b32 v68, v87 offset:39440
    v_cvt_pk_bf16_f32 v43, v30, v31
    v_exp_f32 v33, v33
    v_exp_f32 v34, v34
    v_exp_f32 v35, v35
    v_mfma_f32_32x32x16_bf16 v[48:63], v[72:75], v[40:43], v[48:63]
    ds_read_b128 v[72:75], v88 offset:37120
    v_cvt_pk_bf16_f32 v44, v32, v33
    v_exp_f32 v36, v36
    v_exp_f32 v37, v37
    v_cvt_pk_bf16_f32 v45, v34, v35
    s_waitcnt lgkmcnt(8)
    v_mfma_f32_32x32x16_bf16 v[96:111], v[116:119], v[124:127], v[96:111]
    ds_read2_b32 v[116:117], v160 offset0:8 offset1:9
    ds_read2_b32 v[118:119], v160 offset0:10 offset1:11
    ds_read_b128 v[124:127], v161 offset:2496
    v_exp_f32 v38, v38
    v_exp_f32 v39, v39
    v_cvt_pk_bf16_f32 v46, v36, v37
    v_cvt_pk_bf16_f32 v47, v38, v39
    v_add_u32 v86, 37120, v86
    v_add_u32 v87, 37120, v87
    v_add_u32 v88, 37120, v88
    v_add_u32 v89, 37120, v89
    s_bitcmp1_b32 s95, 2
    s_cbranch_scc0 L_pr111
    s_setprio 1
L_pr111:
    s_waitcnt lgkmcnt(9)
    v_mfma_f32_32x32x16_bf16 v[24:39], v[64:67], v[80:83], 0
    ds_read_b128 v[64:67], v86 offset:4640
    v_exp_f32 v8, v8
    v_exp_f32 v9, v9
    v_exp_f32 v10, v10
    v_mfma_f32_32x32x16_bf16 v[48:63], v[76:79], v[44:47], v[48:63]
    ds_read_b128 v[76:79], v89 offset:0
    v_exp_f32 v11, v11
    v_cvt_pk_bf16_f32 v40, v8, v9
    v_exp_f32 v12, v12
    v_cvt_pk_bf16_f32 v41, v10, v11
    v_exp_f32 v13, v13
    s_waitcnt lgkmcnt(7)
    v_mfma_f32_32x32x16_bf16 v[96:111], v[112:115], v[120:123], v[96:111]
    ds_read2_b32 v[112:113], v160 offset0:16 offset1:17
    ds_read2_b32 v[114:115], v160 offset0:18 offset1:19
    ds_read_b128 v[120:123], v161 offset:464
    v_exp_f32 v14, v14
    v_exp_f32 v15, v15
    v_cvt_pk_bf16_f32 v42, v12, v13
    v_exp_f32 v16, v16
    s_waitcnt lgkmcnt(8)
    v_mfma_f32_32x32x8_bf16 v[24:39], v[68:69], v[84:85], v[24:39]
    ds_read_b32 v68, v87 offset:4640
    v_cvt_pk_bf16_f32 v43, v14, v15
    v_exp_f32 v17, v17
    v_exp_f32 v18, v18
    v_exp_f32 v19, v19
    v_mfma_f32_32x32x16_bf16 v[48:63], v[72:75], v[40:43], v[48:63]
    ds_read_b128 v[72:75], v88 offset:2320
    v_cvt_pk_bf16_f32 v44, v16, v17
    v_exp_f32 v20, v20
    v_exp_f32 v21, v21
    v_cvt_pk_bf16_f32 v45, v18, v19
    s_waitcnt lgkmcnt(7)
    v_mfma_f32_32x32x16_bf16 v[96:111], v[116:119], v[124:127], v[96:111]
    ds_read2_b32 v[116:117], v160 offset0:24 offset1:25
    ds_read2_b32 v[118:119], v160 offset0:26 offset1:27
    ds_read_b128 v[124:127], v161 offset:2512
    v_exp_f32 v22, v22
    v_exp_f32 v23, v23
    v_cvt_pk_bf16_f32 v46, v20, v21
    v_cvt_pk_bf16_f32 v47, v22, v23
    s_waitcnt lgkmcnt(8)
    v_mfma_f32_32x32x16_bf16 v[8:23], v[64:67], v[80:83], 0
    ds_read_b128 v[64:67], v86 offset:6960
    v_exp_f32 v24, v24
    v_exp_f32 v25, v25
    v_exp_f32 v26, v26
    v_mfma_f32_32x32x16_bf16 v[48:63], v[76:79], v[44:47], v[48:63]
    ds_read_b128 v[76:79], v89 offset:2320
    v_exp_f32 v27, v27
    v_cvt_pk_bf16_f32 v40, v24, v25
    v_exp_f32 v28, v28
    v_cvt_pk_bf16_f32 v41, v26, v27
    v_exp_f32 v29, v29
    s_waitcnt lgkmcnt(7)
    v_mfma_f32_32x32x16_bf16 v[96:111], v[112:115], v[120:123], v[96:111]
    ds_read2_b32 v[112:113], v160 offset0:32 offset1:33
    ds_read2_b32 v[114:115], v160 offset0:34 offset1:35
    ds_read_b128 v[120:123], v161 offset:480
    v_exp_f32 v30, v30
    v_exp_f32 v31, v31
    v_cvt_pk_bf16_f32 v42, v28, v29
    v_exp_f32 v32, v32
    s_waitcnt lgkmcnt(8)
    v_mfma_f32_32x32x8_bf16 v[8:23], v[68:69], v[84:85], v[8:23]
    ds_read_b32 v68, v87 offset:6960
    v_cvt_pk_bf16_f32 v43, v30, v31
    v_exp_f32 v33, v33
    v_exp_f32 v34, v34
    v_exp_f32 v35, v35
    v_mfma_f32_32x32x16_bf16 v[48:63], v[72:75], v[40:43], v[48:63]
    ds_read_b128 v[72:75], v88 offset:4640
    v_cvt_pk_bf16_f32 v44, v32, v33
    v_exp_f32 v36, v36
    v_exp_f32 v37, v37
    v_cvt_pk_bf16_f32 v45, v34, v35
    s_waitcnt lgkmcnt(7)
    v_mfma_f32_32x32x16_bf16 v[96:111], v[116:119], v[124:127], v[96:111]
    ds_read2_b32 v[116:117], v160 offset0:40 offset1:41
    ds_read2_b32 v[118:119], v160 offset0:42 offset1:43
    ds_read_b128 v[124:127], v161 offset:2528
    v_exp_f32 v38, v38
    v_exp_f32 v39, v39
    v_cvt_pk_bf16_f32 v46, v36, v37
    v_cvt_pk_bf16_f32 v47, v38, v39
    s_waitcnt lgkmcnt(8)
    v_mfma_f32_32x32x16_bf16 v[24:39], v[64:67], v[80:83], 0
    ds_read_b128 v[64:67], v86 offset:9280
    v_exp_f32 v8, v8
    v_exp_f32 v9, v9
    v_exp_f32 v10, v10
    v_mfma_f32_32x32x16_bf16 v[48:63], v[76:79], v[44:47], v[48:63]
    ds_read_b128 v[76:79], v89 offset:4640
    v_exp_f32 v11, v11
    v_cvt_pk_bf16_f32 v40, v8, v9
    v_exp_f32 v12, v12
    v_cvt_pk_bf16_f32 v41, v10, v11
    v_exp_f32 v13, v13
    s_waitcnt lgkmcnt(7)
    v_mfma_f32_32x32x16_bf16 v[96:111], v[112:115], v[120:123], v[96:111]
    ds_read2_b32 v[112:113], v160 offset0:48 offset1:49
    ds_read2_b32 v[114:115], v160 offset0:50 offset1:51
    ds_read_b128 v[120:123], v161 offset:496
    v_exp_f32 v14, v14
    v_exp_f32 v15, v15
    v_cvt_pk_bf16_f32 v42, v12, v13
    v_exp_f32 v16, v16
    s_waitcnt lgkmcnt(8)
    v_mfma_f32_32x32x8_bf16 v[24:39], v[68:69], v[84:85], v[24:39]
    ds_read_b32 v68, v87 offset:9280
    v_cvt_pk_bf16_f32 v43, v14, v15
    v_exp_f32 v17, v17
    v_exp_f32 v18, v18
    v_exp_f32 v19, v19
    v_mfma_f32_32x32x16_bf16 v[48:63], v[72:75], v[40:43], v[48:63]
    ds_read_b128 v[72:75], v88 offset:6960
    v_cvt_pk_bf16_f32 v44, v16, v17
    v_exp_f32 v20, v20
    v_exp_f32 v21, v21
    v_cvt_pk_bf16_f32 v45, v18, v19
    s_waitcnt lgkmcnt(7)
    v_mfma_f32_32x32x16_bf16 v[96:111], v[116:119], v[124:127], v[96:111]
    ds_read2_b32 v[116:117], v160 offset0:56 offset1:57
    ds_read2_b32 v[118:119], v160 offset0:58 offset1:59
    ds_read_b128 v[124:127], v161 offset:2544
    v_exp_f32 v22, v22
    v_exp_f32 v23, v23
    v_cvt_pk_bf16_f32 v46, v20, v21
    v_cvt_pk_bf16_f32 v47, v22, v23
    s_waitcnt lgkmcnt(8)
    v_mfma_f32_32x32x16_bf16 v[8:23], v[64:67], v[80:83], 0
    ds_read_b128 v[64:67], v86 offset:11600
    v_exp_f32 v24, v24
    v_exp_f32 v25, v25
    v_exp_f32 v26, v26
    v_mfma_f32_32x32x16_bf16 v[48:63], v[76:79], v[44:47], v[48:63]
    ds_read_b128 v[76:79], v89 offset:6960
    v_exp_f32 v27, v27
    v_cvt_pk_bf16_f32 v40, v24, v25
    v_exp_f32 v28, v28
    v_cvt_pk_bf16_f32 v41, v26, v27
    v_exp_f32 v29, v29
    s_waitcnt lgkmcnt(7)
    v_mfma_f32_32x32x16_bf16 v[96:111], v[112:115], v[120:123], v[96:111]
    v_exp_f32 v30, v30
    v_exp_f32 v31, v31
    v_cvt_pk_bf16_f32 v42, v28, v29
    v_exp_f32 v32, v32
    s_waitcnt lgkmcnt(5)
    v_mfma_f32_32x32x8_bf16 v[8:23], v[68:69], v[84:85], v[8:23]
    ds_read_b32 v68, v87 offset:11600
    v_cvt_pk_bf16_f32 v43, v30, v31
    v_exp_f32 v33, v33
    v_exp_f32 v34, v34
    v_exp_f32 v35, v35
    v_mfma_f32_32x32x16_bf16 v[48:63], v[72:75], v[40:43], v[48:63]
    ds_read_b128 v[72:75], v88 offset:9280
    v_cvt_pk_bf16_f32 v44, v32, v33
    v_exp_f32 v36, v36
    v_exp_f32 v37, v37
    v_cvt_pk_bf16_f32 v45, v34, v35
    s_waitcnt lgkmcnt(4)
    v_mfma_f32_32x32x16_bf16 v[96:111], v[116:119], v[124:127], v[96:111]
    v_exp_f32 v38, v38
    v_exp_f32 v39, v39
    v_cvt_pk_bf16_f32 v46, v36, v37
    v_cvt_pk_bf16_f32 v47, v38, v39
    v_mov_b32 v91, 157296
    s_mov_b64 exec, 1
    ds_add_u32 v91, v92
    s_mov_b64 exec, -1
    s_waitcnt lgkmcnt(3)
    v_mfma_f32_32x32x16_bf16 v[24:39], v[64:67], v[80:83], 0
    ds_read_b128 v[64:67], v86 offset:13920
    v_exp_f32 v8, v8
    v_exp_f32 v9, v9
    v_exp_f32 v10, v10
    v_exp_f32 v11, v11
    v_cvt_pk_bf16_f32 v40, v8, v9
    v_mfma_f32_32x32x16_bf16 v[48:63], v[76:79], v[44:47], v[48:63]
    ds_read_b128 v[76:79], v89 offset:9280
    v_exp_f32 v12, v12
    v_exp_f32 v13, v13
    v_cvt_pk_bf16_f32 v41, v10, v11
    v_exp_f32 v14, v14
    v_exp_f32 v15, v15
    v_cvt_pk_bf16_f32 v42, v12, v13
    s_waitcnt lgkmcnt(3)
    v_mfma_f32_32x32x8_bf16 v[24:39], v[68:69], v[84:85], v[24:39]
    ds_read_b32 v68, v87 offset:13920
    v_exp_f32 v16, v16
    v_cvt_pk_bf16_f32 v43, v14, v15
    v_exp_f32 v17, v17
    v_exp_f32 v18, v18
    v_exp_f32 v19, v19
    v_cvt_pk_bf16_f32 v44, v16, v17
    v_mfma_f32_32x32x16_bf16 v[48:63], v[72:75], v[40:43], v[48:63]
    ds_read_b128 v[72:75], v88 offset:11600
    v_exp_f32 v20, v20
    v_exp_f32 v21, v21
    v_cvt_pk_bf16_f32 v45, v18, v19
    v_exp_f32 v22, v22
    v_exp_f32 v23, v23
    v_cvt_pk_bf16_f32 v46, v20, v21
    v_cvt_pk_bf16_f32 v47, v22, v23
    v_mov_b32 v91, 157284
    s_mov_b32 s89, 2097152
L_spin112:
    ds_read_b32 v93, v91
    s_waitcnt lgkmcnt(0)
    v_readfirstlane_b32 s88, v93
    s_nop 0
    s_cmp_ge_u32 s88, 2
    s_cbranch_scc1 L_spun113
    s_sleep 1
    s_sub_u32 s89, s89, 1
    s_cbranch_scc0 L_spin112
L_spun113:
    v_cvt_pk_bf16_f32 v120, v96, v97
    v_cvt_pk_bf16_f32 v121, v98, v99
    v_cvt_pk_bf16_f32 v122, v100, v101
    v_cvt_pk_bf16_f32 v123, v102, v103
    v_min_u32 v120, -2, v120
    v_min_u32 v121, -2, v121
    v_min_u32 v122, -2, v122
    v_min_u32 v123, -2, v123
    s_nop 0
    v_permlane32_swap_b32 v120, v122
    v_permlane32_swap_b32 v121, v123
    buffer_store_dwordx4 v[120:123], v162, s[36:39], s93 offen offset:0 sc1
    v_cvt_pk_bf16_f32 v124, v104, v105
    v_cvt_pk_bf16_f32 v125, v106, v107
    v_cvt_pk_bf16_f32 v126, v108, v109
    v_cvt_pk_bf16_f32 v127, v110, v111
    v_min_u32 v124, -2, v124
    v_min_u32 v125, -2, v125
    v_min_u32 v126, -2, v126
    v_min_u32 v127, -2, v127
    s_nop 0
    v_permlane32_swap_b32 v124, v126
    v_permlane32_swap_b32 v125, v127
    buffer_store_dwordx4 v[124:127], v162, s[36:39], s93 offen offset:32 sc1
    v_mfma_f32_32x32x16_bf16 v[8:23], v[64:67], v[80:83], 0
    ds_read_b128 v[64:67], v86 offset:16240
    v_exp_f32 v24, v24
    v_exp_f32 v25, v25
    v_exp_f32 v26, v26
    v_exp_f32 v27, v27
    v_cvt_pk_bf16_f32 v40, v24, v25
    v_mfma_f32_32x32x16_bf16 v[48:63], v[76:79], v[44:47], v[48:63]
    ds_read_b128 v[76:79], v89 offset:11600
    v_exp_f32 v28, v28
    v_exp_f32 v29, v29
    v_cvt_pk_bf16_f32 v41, v26, v27
    v_exp_f32 v30, v30
    v_exp_f32 v31, v31
    v_cvt_pk_bf16_f32 v42, v28, v29
    v_mfma_f32_32x32x8_bf16 v[8:23], v[68:69], v[84:85], v[8:23]
    ds_read_b32 v68, v87 offset:16240
    v_exp_f32 v32, v32
    v_cvt_pk_bf16_f32 v43, v30, v31
    v_exp_f32 v33, v33
    v_exp_f32 v34, v34
    v_exp_f32 v35, v35
    v_cvt_pk_bf16_f32 v44, v32, v33
    v_mfma_f32_32x32x16_bf16 v[48:63], v[72:75], v[40:43], v[48:63]
    ds_read_b128 v[72:75], v88 offset:13920
    v_exp_f32 v36, v36
    v_exp_f32 v37, v37
    v_cvt_pk_bf16_f32 v45, v34, v35
    v_exp_f32 v38, v38
    v_exp_f32 v39, v39
    v_cvt_pk_bf16_f32 v46, v36, v37
    v_cvt_pk_bf16_f32 v47, v38, v39
    s_bitcmp1_b32 s95, 2
    s_cbranch_scc0 L_pr114
    s_setprio 0
L_pr114:
    s_waitcnt lgkmcnt(2)
    v_mfma_f32_32x32x16_bf16 v[24:39], v[64:67], v[80:83], 0
    ds_read_b128 v[64:67], v86 offset:18560
    v_exp_f32 v8, v8
    v_exp_f32 v9, v9
    v_exp_f32 v10, v10
    v_exp_f32 v11, v11
    v_cvt_pk_bf16_f32 v40, v8, v9
    v_mfma_f32_32x32x16_bf16 v[48:63], v[76:79], v[44:47], v[48:63]
    ds_read_b128 v[76:79], v89 offset:13920
    v_exp_f32 v12, v12
    v_exp_f32 v13, v13
    v_cvt_pk_bf16_f32 v41, v10, v11
    v_exp_f32 v14, v14
    v_exp_f32 v15, v15
    v_cvt_pk_bf16_f32 v42, v12, v13
    s_waitcnt lgkmcnt(2)
    v_mfma_f32_32x32x8_bf16 v[24:39], v[68:69], v[84:85], v[24:39]
    ds_read_b32 v68, v87 offset:18560
    v_exp_f32 v16, v16
    v_cvt_pk_bf16_f32 v43, v14, v15
    v_exp_f32 v17, v17
    v_exp_f32 v18, v18
    v_exp_f32 v19, v19
    v_cvt_pk_bf16_f32 v44, v16, v17
    v_mfma_f32_32x32x16_bf16 v[48:63], v[72:75], v[40:43], v[48:63]
    ds_read_b128 v[72:75], v88 offset:16240
    v_exp_f32 v20, v20
    v_exp_f32 v21, v21
    v_cvt_pk_bf16_f32 v45, v18, v19
    v_exp_f32 v22, v22
    v_exp_f32 v23, v23
    v_cvt_pk_bf16_f32 v46, v20, v21
    v_cvt_pk_bf16_f32 v47, v22, v23
    s_waitcnt lgkmcnt(2)
    v_mfma_f32_32x32x16_bf16 v[8:23], v[64:67], v[80:83], 0
    ds_read_b128 v[64:67], v86 offset:20880
    v_exp_f32 v24, v24
    v_exp_f32 v25, v25
    v_exp_f32 v26, v26
    v_exp_f32 v27, v27
    v_cvt_pk_bf16_f32 v40, v24, v25
    v_mfma_f32_32x32x16_bf16 v[48:63], v[76:79], v[44:47], v[48:63]
    ds_read_b128 v[76:79], v89 offset:16240
    v_exp_f32 v28, v28
    v_exp_f32 v29, v29
    v_cvt_pk_bf16_f32 v41, v26, v27
    v_exp_f32 v30, v30
    v_exp_f32 v31, v31
    v_cvt_pk_bf16_f32 v42, v28, v29
    s_waitcnt lgkmcnt(2)
    v_mfma_f32_32x32x8_bf16 v[8:23], v[68:69], v[84:85], v[8:23]
    ds_read_b32 v68, v87 offset:20880
    v_exp_f32 v32, v32
    v_cvt_pk_bf16_f32 v43, v30, v31
    v_exp_f32 v33, v33
    v_exp_f32 v34, v34
    v_exp_f32 v35, v35
    v_cvt_pk_bf16_f32 v44, v32, v33
    v_mfma_f32_32x32x16_bf16 v[48:63], v[72:75], v[40:43], v[48:63]
    ds_read_b128 v[72:75], v88 offset:18560
    v_exp_f32 v36, v36
    v_exp_f32 v37, v37
    v_cvt_pk_bf16_f32 v45, v34, v35
    v_exp_f32 v38, v38
    v_exp_f32 v39, v39
    v_cvt_pk_bf16_f32 v46, v36, v37
    v_cvt_pk_bf16_f32 v47, v38, v39
    s_bitcmp1_b32 s95, 2
    s_cbranch_scc0 L_pr115
    s_setprio 1
L_pr115:
    s_waitcnt lgkmcnt(2)
    v_mfma_f32_32x32x16_bf16 v[24:39], v[64:67], v[80:83], 0
    ds_read_b128 v[64:67], v86 offset:23200
    v_exp_f32 v8, v8
    v_exp_f32 v9, v9
    v_exp_f32 v10, v10
    v_exp_f32 v11, v11
    v_cvt_pk_bf16_f32 v40, v8, v9
    v_mfma_f32_32x32x16_bf16 v[48:63], v[76:79], v[44:47], v[48:63]
    ds_read_b128 v[76:79], v89 offset:18560
    v_exp_f32 v12, v12
    v_exp_f32 v13, v13
    v_cvt_pk_bf16_f32 v41, v10, v11
    v_exp_f32 v14, v14
    v_exp_f32 v15, v15
    v_cvt_pk_bf16_f32 v42, v12, v13
    s_waitcnt lgkmcnt(2)
    v_mfma_f32_32x32x8_bf16 v[24:39], v[68:69], v[84:85], v[24:39]
    ds_read_b32 v68, v87 offset:23200
    v_exp_f32 v16, v16
    v_cvt_pk_bf16_f32 v43, v14, v15
    v_exp_f32 v17, v17
    v_exp_f32 v18, v18
    v_exp_f32 v19, v19
    v_cvt_pk_bf16_f32 v44, v16, v17
    v_mfma_f32_32x32x16_bf16 v[48:63], v[72:75], v[40:43], v[48:63]
    ds_read_b128 v[72:75], v88 offset:20880
    v_exp_f32 v20, v20
    v_exp_f32 v21, v21
    v_cvt_pk_bf16_f32 v45, v18, v19
    v_exp_f32 v22, v22
    v_exp_f32 v23, v23
    v_cvt_pk_bf16_f32 v46, v20, v21
    v_cvt_pk_bf16_f32 v47, v22, v23
    s_waitcnt lgkmcnt(2)
    v_mfma_f32_32x32x16_bf16 v[8:23], v[64:67], v[80:83], 0
    ds_read_b128 v[64:67], v86 offset:25520
    v_exp_f32 v24, v24
    v_exp_f32 v25, v25
    v_exp_f32 v26, v26
    v_exp_f32 v27, v27
    v_cvt_pk_bf16_f32 v40, v24, v25
    v_mfma_f32_32x32x16_bf16 v[48:63], v[76:79], v[44:47], v[48:63]
    ds_read_b128 v[76:79], v89 offset:20880
    v_exp_f32 v28, v28
    v_exp_f32 v29, v29
    v_cvt_pk_bf16_f32 v41, v26, v27
    v_exp_f32 v30, v30
    v_exp_f32 v31, v31
    v_cvt_pk_bf16_f32 v42, v28, v29
    s_waitcnt lgkmcnt(2)
    v_mfma_f32_32x32x8_bf16 v[8:23], v[68:69], v[84:85], v[8:23]
    ds_read_b32 v68, v87 offset:25520
    v_exp_f32 v32, v32
    v_cvt_pk_bf16_f32 v43, v30, v31
    v_exp_f32 v33, v33
    v_exp_f32 v34, v34
    v_exp_f32 v35, v35
    v_cvt_pk_bf16_f32 v44, v32, v33
    v_mfma_f32_32x32x16_bf16 v[48:63], v[72:75], v[40:43], v[48:63]
    ds_read_b128 v[72:75], v88 offset:23200
    v_exp_f32 v36, v36
    v_exp_f32 v37, v37
    v_cvt_pk_bf16_f32 v45, v34, v35
    v_exp_f32 v38, v38
    v_exp_f32 v39, v39
    v_cvt_pk_bf16_f32 v46, v36, v37
    v_cvt_pk_bf16_f32 v47, v38, v39
    s_waitcnt lgkmcnt(2)
    v_mfma_f32_32x32x16_bf16 v[24:39], v[64:67], v[80:83], 0
    ds_read_b128 v[64:67], v86 offset:27840
    v_exp_f32 v8, v8
    v_exp_f32 v9, v9
    v_exp_f32 v10, v10
    v_exp_f32 v11, v11
    v_cvt_pk_bf16_f32 v40, v8, v9
    v_mfma_f32_32x32x16_bf16 v[48:63], v[76:79], v[44:47], v[48:63]
    ds_read_b128 v[76:79], v89 offset:23200
    v_exp_f32 v12, v12
    v_exp_f32 v13, v13
    v_cvt_pk_bf16_f32 v41, v10, v11
    v_exp_f32 v14, v14
    v_exp_f32 v15, v15
    v_cvt_pk_bf16_f32 v42, v12, v13
    s_waitcnt lgkmcnt(2)
    v_mfma_f32_32x32x8_bf16 v[24:39], v[68:69], v[84:85], v[24:39]
    ds_read_b32 v68, v87 offset:27840
    v_exp_f32 v16, v16
    v_cvt_pk_bf16_f32 v43, v14, v15
    v_exp_f32 v17, v17
    v_exp_f32 v18, v18
    v_exp_f32 v19, v19
    v_cvt_pk_bf16_f32 v44, v16, v17
    v_mfma_f32_32x32x16_bf16 v[48:63], v[72:75], v[40:43], v[48:63]
    ds_read_b128 v[72:75], v88 offset:25520
    v_exp_f32 v20, v20
    v_exp_f32 v21, v21
    v_cvt_pk_bf16_f32 v45, v18, v19
    v_exp_f32 v22, v22
    v_exp_f32 v23, v23
    v_cvt_pk_bf16_f32 v46, v20, v21
    v_cvt_pk_bf16_f32 v47, v22, v23
    v_mov_b32 v91, 157280
    s_mov_b64 exec, 1
    ds_add_u32 v91, v92
    s_mov_b64 exec, -1
    s_waitcnt lgkmcnt(3)
    v_mfma_f32_32x32x16_bf16 v[8:23], v[64:67], v[80:83], 0
    ds_read_b128 v[64:67], v86 offset:30160
    v_exp_f32 v24, v24
    v_exp_f32 v25, v25
    v_exp_f32 v26, v26
    v_exp_f32 v27, v27
    v_cvt_pk_bf16_f32 v40, v24, v25
    v_mfma_f32_32x32x16_bf16 v[48:63], v[76:79], v[44:47], v[48:63]
    ds_read_b128 v[76:79], v89 offset:25520
    v_exp_f32 v28, v28
    v_exp_f32 v29, v29
    v_cvt_pk_bf16_f32 v41, v26, v27
    v_exp_f32 v30, v30
    v_exp_f32 v31, v31
    v_cvt_pk_bf16_f32 v42, v28, v29
    s_waitcnt lgkmcnt(3)
    v_mfma_f32_32x32x8_bf16 v[8:23], v[68:69], v[84:85], v[8:23]
    ds_read_b32 v68, v87 offset:30160
    v_exp_f32 v32, v32
    v_cvt_pk_bf16_f32 v43, v30, v31
    v_exp_f32 v33, v33
    v_exp_f32 v34, v34
    v_exp_f32 v35, v35
    v_cvt_pk_bf16_f32 v44, v32, v33
    v_mfma_f32_32x32x16_bf16 v[48:63], v[72:75], v[40:43], v[48:63]
    ds_read_b128 v[72:75], v88 offset:27840
    v_exp_f32 v36, v36
    v_exp_f32 v37, v37
    v_cvt_pk_bf16_f32 v45, v34, v35
    v_exp_f32 v38, v38
    v_exp_f32 v39, v39
    v_cvt_pk_bf16_f32 v46, v36, v37
    v_cvt_pk_bf16_f32 v47, v38, v39
    s_waitcnt lgkmcnt(2)
    v_mfma_f32_32x32x16_bf16 v[24:39], v[64:67], v[80:83], 0
    ds_read_b128 v[64:67], v86 offset:32480
    v_exp_f32 v8, v8
    v_exp_f32 v9, v9
    v_exp_f32 v10, v10
    v_exp_f32 v11, v11
    v_cvt_pk_bf16_f32 v40, v8, v9
    v_mfma_f32_32x32x16_bf16 v[48:63], v[76:79], v[44:47], v[48:63]
    ds_read_b128 v[76:79], v89 offset:27840
    v_exp_f32 v12, v12
    v_exp_f32 v13, v13
    v_cvt_pk_bf16_f32 v41, v10, v11
    v_exp_f32 v14, v14
    v_exp_f32 v15, v15
    v_cvt_pk_bf16_f32 v42, v12, v13
    s_waitcnt lgkmcnt(2)
    v_mfma_f32_32x32x8_bf16 v[24:39], v[68:69], v[84:85], v[24:39]
    ds_read_b32 v68, v87 offset:32480
    v_exp_f32 v16, v16
    v_cvt_pk_bf16_f32 v43, v14, v15
    v_exp_f32 v17, v17
    v_exp_f32 v18, v18
    v_exp_f32 v19, v19
    v_cvt_pk_bf16_f32 v44, v16, v17
    v_mfma_f32_32x32x16_bf16 v[48:63], v[72:75], v[40:43], v[48:63]
    ds_read_b128 v[72:75], v88 offset:30160
    v_exp_f32 v20, v20
    v_exp_f32 v21, v21
    v_cvt_pk_bf16_f32 v45, v18, v19
    v_exp_f32 v22, v22
    v_exp_f32 v23, v23
    v_cvt_pk_bf16_f32 v46, v20, v21
    v_cvt_pk_bf16_f32 v47, v22, v23
    s_waitcnt lgkmcnt(2)
    v_mfma_f32_32x32x16_bf16 v[8:23], v[64:67], v[80:83], 0
    ds_read_b128 v[64:67], v86 offset:34800
    v_exp_f32 v24, v24
    v_exp_f32 v25, v25
    v_exp_f32 v26, v26
    v_exp_f32 v27, v27
    v_cvt_pk_bf16_f32 v40, v24, v25
    v_mfma_f32_32x32x16_bf16 v[48:63], v[76:79], v[44:47], v[48:63]
    ds_read_b128 v[76:79], v89 offset:30160
    v_exp_f32 v28, v28
    v_exp_f32 v29, v29
    v_cvt_pk_bf16_f32 v41, v26, v27
    v_exp_f32 v30, v30
    v_exp_f32 v31, v31
    v_cvt_pk_bf16_f32 v42, v28, v29
    s_waitcnt lgkmcnt(2)
    v_mfma_f32_32x32x8_bf16 v[8:23], v[68:69], v[84:85], v[8:23]
    ds_read_b32 v68, v87 offset:34800
    v_exp_f32 v32, v32
    v_cvt_pk_bf16_f32 v43, v30, v31
    v_exp_f32 v33, v33
    v_exp_f32 v34, v34
    v_exp_f32 v35, v35
    v_cvt_pk_bf16_f32 v44, v32, v33
    v_mfma_f32_32x32x16_bf16 v[48:63], v[72:75], v[40:43], v[48:63]
    ds_read_b128 v[72:75], v88 offset:32480
    v_exp_f32 v36, v36
    v_exp_f32 v37, v37
    v_cvt_pk_bf16_f32 v45, v34, v35
    v_exp_f32 v38, v38
    v_exp_f32 v39, v39
    v_cvt_pk_bf16_f32 v46, v36, v37
    v_cvt_pk_bf16_f32 v47, v38, v39
    s_bitcmp1_b32 s95, 2
    s_cbranch_scc0 L_pr116
    s_setprio 0
L_pr116:
    s_waitcnt lgkmcnt(2)
    v_mfma_f32_32x32x16_bf16 v[24:39], v[64:67], v[80:83], 0
    ds_read_b128 v[64:67], v86 offset:37120
    v_exp_f32 v8, v8
    v_exp_f32 v9, v9
    v_exp_f32 v10, v10
    v_exp_f32 v11, v11
    v_cvt_pk_bf16_f32 v40, v8, v9
    v_mfma_f32_32x32x16_bf16 v[48:63], v[76:79], v[44:47], v[48:63]
    ds_read_b128 v[76:79], v89 offset:32480
    v_exp_f32 v12, v12
    v_exp_f32 v13, v13
    v_cvt_pk_bf16_f32 v41, v10, v11
    v_exp_f32 v14, v14
    v_exp_f32 v15, v15
    v_cvt_pk_bf16_f32 v42, v12, v13
    s_waitcnt lgkmcnt(2)
    v_mfma_f32_32x32x8_bf16 v[24:39], v[68:69], v[84:85], v[24:39]
    ds_read_b32 v68, v87 offset:37120
    v_exp_f32 v16, v16
    v_cvt_pk_bf16_f32 v43, v14, v15
    v_exp_f32 v17, v17
    v_exp_f32 v18, v18
    v_exp_f32 v19, v19
    v_cvt_pk_bf16_f32 v44, v16, v17
    v_mfma_f32_32x32x16_bf16 v[48:63], v[72:75], v[40:43], v[48:63]
    ds_read_b128 v[72:75], v88 offset:34800
    v_exp_f32 v20, v20
    v_exp_f32 v21, v21
    v_cvt_pk_bf16_f32 v45, v18, v19
    v_exp_f32 v22, v22
    v_exp_f32 v23, v23
    v_cvt_pk_bf16_f32 v46, v20, v21
    v_cvt_pk_bf16_f32 v47, v22, v23
    s_waitcnt lgkmcnt(2)
    v_mfma_f32_32x32x16_bf16 v[8:23], v[64:67], v[80:83], 0
    ds_read_b128 v[64:67], v86 offset:39440
    v_exp_f32 v24, v24
    v_exp_f32 v25, v25
    v_exp_f32 v26, v26
    v_exp_f32 v27, v27
    v_cvt_pk_bf16_f32 v40, v24, v25
    v_mfma_f32_32x32x16_bf16 v[48:63], v[76:79], v[44:47], v[48:63]
    ds_read_b128 v[76:79], v89 offset:34800
    v_exp_f32 v28, v28
    v_exp_f32 v29, v29
    v_cvt_pk_bf16_f32 v41, v26, v27
    v_exp_f32 v30, v30
    v_exp_f32 v31, v31
    v_cvt_pk_bf16_f32 v42, v28, v29
    s_waitcnt lgkmcnt(2)
    v_mfma_f32_32x32x8_bf16 v[8:23], v[68:69], v[84:85], v[8:23]
    ds_read_b32 v68, v87 offset:39440
    v_exp_f32 v32, v32
    v_cvt_pk_bf16_f32 v43, v30, v31
    v_exp_f32 v33, v33
    v_exp_f32 v34, v34
    v_exp_f32 v35, v35
    v_cvt_pk_bf16_f32 v44, v32, v33
    v_mfma_f32_32x32x16_bf16 v[48:63], v[72:75], v[40:43], v[48:63]
    ds_read_b128 v[72:75], v88 offset:37120
    v_exp_f32 v36, v36
    v_exp_f32 v37, v37
    v_cvt_pk_bf16_f32 v45, v34, v35
    v_exp_f32 v38, v38
    v_exp_f32 v39, v39
    v_cvt_pk_bf16_f32 v46, v36, v37
    v_cvt_pk_bf16_f32 v47, v38, v39
    s_branch L_fini
L_truemax:
    v_mov_b32 v3, 157208
    s_mov_b32 s89, 2097152
L_spin117:
    ds_read_b32 v6, v3
    s_waitcnt lgkmcnt(0)
    v_readfirstlane_b32 s88, v6
    s_nop 0
    s_cmp_ge_u32 s88, 2
    s_cbranch_scc1 L_spun118
    s_sleep 1
    s_sub_u32 s89, s89, 1
    s_cbranch_scc0 L_spin117
L_spun118:
    v_mov_b32 v85, 0
    v_mov_b32 v5, 0xff800000
    s_mov_b32 s60, 64
L_fb:
    ds_read_b128 v[64:67], v86 offset:0
    ds_read_b32 v68, v87 offset:0
    s_waitcnt lgkmcnt(0)
    v_mfma_f32_32x32x16_bf16 v[8:23], v[64:67], v[80:83], 0
    v_mfma_f32_32x32x8_bf16 v[8:23], v[68:69], v[84:85], v[8:23]
    v_add_u32 v86, 2320, v86
    v_add_u32 v87, 2320, v87
    s_nop 9
    v_max3_f32 v5, v5, v8, v9
    v_max3_f32 v5, v5, v10, v11
    v_max3_f32 v5, v5, v12, v13
    v_max3_f32 v5, v5, v14, v15
    v_max3_f32 v5, v5, v16, v17
    v_max3_f32 v5, v5, v18, v19
    v_max3_f32 v5, v5, v20, v21
    v_max3_f32 v5, v5, v22, v23
    s_sub_u32 s60, s60, 1
    s_cmp_lg_u32 s60, 0
    s_cbranch_scc1 L_fb
    v_subrev_u32 v86, 148480, v86
    v_subrev_u32 v87, 148480, v87
    v_mov_b32 v6, v5
    s_nop 1
    v_permlane32_swap_b32 v5, v6
    v_max_f32 v5, v5, v6
    v_sub_f32 v5, 0, v5
    v_cvt_pk_bf16_f32 v6, v5, v5
    v_and_b32 v7, 0xffff0000, v6
    v_sub_f32 v5, v5, v7
    v_cvt_pk_bf16_f32 v7, v5, v5
    v_and_b32 v3, 0xffff0000, v7
    v_sub_f32 v5, v5, v3
    v_cvt_pk_bf16_f32 v5, v5, 0
    v_and_b32 v6, 0xffff, v6
    v_or_b32 v6, v6, v3
    v_cndmask_b32 v85, v6, v5, s[64:65]
    v_mov_b32 v69, 0x3f803f80
    ds_read_b128 v[64:67], v86 offset:0
    ds_read_b32 v68, v87 offset:0
    s_branch L_pass
L_end:
    s_endpgm
.section .rodata,"a"
.p2align 6
.amdhsa_kernel concat_heads__grouped_kv_mqa__ssm_conv_h3__prompt_kernel
  .amdhsa_next_free_vgpr 168
  .amdhsa_next_free_sgpr 102
  .amdhsa_accum_offset 168
  .amdhsa_group_segment_fixed_size 0
  .amdhsa_kernarg_size 112
  .amdhsa_user_sgpr_count 2
  .amdhsa_user_sgpr_kernarg_segment_ptr 1
  .amdhsa_system_sgpr_workgroup_id_x 1
.end_amdhsa_kernel
```
